```python
import torch

def _softmax(x, axis=-1):
    return torch.softmax(x, dim=axis)
def _gelu(x):
    return torch.nn.functional.gelu(x, approximate="tanh")
def _silu(x):
    return torch.nn.functional.silu(x)
def _sigmoid(x):
    return torch.sigmoid(x)
def _layernorm(x, axis=-1, eps=1e-5):
    m = x.mean(dim=axis, keepdim=True)
    v = x.var(dim=axis, keepdim=True, unbiased=False)
    return (x - m) / torch.sqrt(v + eps)
def _scatter_add(tgt, idx, src, axis=0):
    return tgt.clone().index_add_(axis, idx, src)
def _segment_sum(src, seg, n):
    out = torch.zeros((n,) + src.shape[1:], dtype=src.dtype)
    return out.index_add_(0, seg, src)
def _pad(x, pw):
    flat = tuple(v for pair in reversed(pw) for v in pair)
    return torch.nn.functional.pad(x, flat)

kernel_name = 'concat_heads__gqa_block_cached__mha_block_cached__near_ridge'

def setup_inputs():

    _w = (lambda a: (lambda t: t.to(torch.bfloat16) if t.is_floating_point() else t)(torch.as_tensor(a)))
    def _A_setup():
        B, Sq, D = 16, 48, 512
        Hq, Hkv, Sk, Dh = 32, 8, 1024, 128
        assert Hq % Hkv == 0, (Hq, Hkv)
        return {
            "x": _w((lambda *s: torch.randn(*s, dtype=torch.bfloat16) * 0.8)(B, Sq, D)),
            "k_cache": _w((lambda *s: torch.randn(*s, dtype=torch.bfloat16) * 0.8)(B, Hkv, Sk, Dh)),
            "v_cache": _w((lambda *s: torch.randn(*s, dtype=torch.bfloat16) * 0.05)(B, Hkv, Sk, Dh)),
            "wq": _w((lambda *s: torch.randn(*s, dtype=torch.bfloat16) * 0.8)(D, Hq * Dh) * (D ** -0.5)),
            "wo": _w((lambda *s: torch.randn(*s, dtype=torch.bfloat16) * 0.05)(Hq * Dh, D) * ((Hq * Dh) ** -0.5)),
        }
    _A_in = _A_setup()

    def _B_setup():
        B, Sq, D = 16, 48, 512
        H, Sk, Dh = 32, 1024, 128
        return {
            "x": _w((lambda *s: torch.randn(*s, dtype=torch.bfloat16) * 0.8)(B, Sq, D)),
            "k_cache": _w((lambda *s: torch.randn(*s, dtype=torch.bfloat16) * 0.8)(B, H, Sk, Dh)),
            "v_cache": _w((lambda *s: torch.randn(*s, dtype=torch.bfloat16) * 0.05)(B, H, Sk, Dh)),
            "wq": _w((lambda *s: torch.randn(*s, dtype=torch.bfloat16) * 0.8)(D, H * Dh) * (D ** -0.5)),
            "wo": _w((lambda *s: torch.randn(*s, dtype=torch.bfloat16) * 0.05)(H * Dh, D) * ((H * Dh) ** -0.5)),
        }
    _B_in = _B_setup()

    return {
        "A_x": _A_in["x"],
        "A_k_cache": _A_in["k_cache"],
        "A_v_cache": _A_in["v_cache"],
        "A_wq": _A_in["wq"],
        "A_wo": _A_in["wo"],
        "B_x": _B_in["x"],
        "B_k_cache": _B_in["k_cache"],
        "B_v_cache": _B_in["v_cache"],
        "B_wq": _B_in["wq"],
        "B_wo": _B_in["wo"],
    }

def reference(A_x, A_k_cache, A_v_cache, A_wq, A_wo, B_x, B_k_cache, B_v_cache, B_wq, B_wo):
    def _A_ref(x, k_cache, v_cache, wq, wo):
        B, Sq, D = x.shape
        Hq, Dh = 32, 128
        Hkv = k_cache.shape[1]
        rep = Hq // Hkv
        q = (lambda x, *d: x.permute(*d))((x @ wq).reshape(B, Sq, Hq, Dh), 0, 2, 1, 3)
        k = (lambda x, n, axis: torch.repeat_interleave(x, n, dim=axis))(k_cache, rep, axis=1)
        v = (lambda x, n, axis: torch.repeat_interleave(x, n, dim=axis))(v_cache, rep, axis=1)
        scores = torch.einsum("bhqd,bhkd->bhqk", q, k) * (Dh ** -0.5)
        p = _softmax(scores, axis=-1)
        o = torch.einsum("bhqk,bhkd->bhqd", p, v)
        return (lambda x, *d: x.permute(*d))(o, 0, 2, 1, 3).reshape(B, Sq, Hq * Dh) @ wo

    def _B_ref(x, k_cache, v_cache, wq, wo):
        B, Sq, D = x.shape
        H, Dh = 32, 128
        q = (lambda x, *d: x.permute(*d))((x @ wq).reshape(B, Sq, H, Dh), 0, 2, 1, 3)
        scores = torch.einsum("bhqd,bhkd->bhqk", q, k_cache) * (Dh ** -0.5)
        p = _softmax(scores, axis=-1)
        o = torch.einsum("bhqk,bhkd->bhqd", p, v_cache)
        return (lambda x, *d: x.permute(*d))(o, 0, 2, 1, 3).reshape(B, Sq, H * Dh) @ wo

    a = _A_ref(A_x, A_k_cache, A_v_cache, A_wq, A_wo)
    b = _B_ref(B_x, B_k_cache, B_v_cache, B_wq, B_wo)
    return torch.concatenate([a, b], axis=-1)
```

```asm
; @launch grid=(256,1,1) block=(256,1,1) lds=163840
.amdgcn_target "amdgcn-amd-amdhsa--gfx950"
.text
.globl concat_heads__gqa_block_cached__mha_block_cached__near_ridge_kernel
.p2align 8
.type concat_heads__gqa_block_cached__mha_block_cached__near_ridge_kernel,@function
concat_heads__gqa_block_cached__mha_block_cached__near_ridge_kernel:
    s_getpc_b64 s[94:95]
    s_cmp_ge_u32 s2, 256
    s_cbranch_scc1 L_attn_end
    s_load_dwordx16 s[4:19], s[0:1], 0
    s_load_dwordx8 s[20:27], s[0:1], 64
    s_load_dwordx2 s[28:29], s[0:1], 96
    v_lshrrev_b32 v14, 6, v0
    s_nop 0
    v_readfirstlane_b32 s3, v14
    v_and_b32 v0, 63, v0
    s_and_b32 s80, s2, 7
    s_lshr_b32 s81, s2, 3
    s_mul_i32 s30, s3, 35328
    v_lshrrev_b32 v248, 4, v0
    v_and_b32 v249, 15, v0
    v_lshlrev_b32 v10, 4, v0
    s_lshl_b32 s31, s3, 13
    v_lshlrev_b32 v15, 7, v0
    v_add_u32 v15, s31, v15
    global_load_dword v243, v15, s[94:95]
    v_and_b32 v15, 15, v0
    v_lshlrev_b32 v15, 7, v15
    v_add_u32 v15, 32768, v15
    global_load_dword v242, v15, s[94:95]
    s_lshl_b32 s31, s3, 2
    v_xor_b32 v14, s31, v249
    v_lshlrev_b32 v14, 4, v14
    v_lshl_add_u32 v1, v248, 11, v14
    v_bfe_u32 v14, v0, 2, 3
    v_lshlrev_b32 v14, 13, v14
    v_lshrrev_b32 v15, 5, v0
    v_lshl_add_u32 v14, v15, 17, v14
    v_and_b32 v15, 3, v0
    v_lshl_add_u32 v2, v15, 4, v14
    v_and_b32 v14, 1, v248
    v_mul_u32_u24 v14, 1056, v14
    v_bfe_u32 v15, v0, 2, 2
    v_lshl_add_u32 v14, v15, 6, v14
    v_lshrrev_b32 v15, 5, v0
    v_lshl_add_u32 v14, v15, 9, v14
    v_and_b32 v15, 3, v0
    v_lshl_add_u32 v14, v15, 3, v14
    v_add_u32 v3, s30, v14
    v_and_b32 v14, 7, v249
    v_mul_u32_u24 v14, 1056, v14
    v_lshrrev_b32 v15, 3, v249
    v_lshl_add_u32 v14, v15, 8, v14
    v_lshl_add_u32 v14, v248, 4, v14
    v_add_u32 v7, s30, v14
    v_bfe_u32 v14, v0, 2, 3
    v_mul_u32_u24 v14, 1056, v14
    v_lshrrev_b32 v15, 5, v0
    v_lshl_add_u32 v14, v15, 8, v14
    v_and_b32 v15, 3, v0
    v_lshl_add_u32 v14, v15, 3, v14
    v_add_u32 v8, s30, v14
    v_mul_u32_u24 v14, 288, v249
    v_add_u32 v14, 141312, v14
    v_lshl_add_u32 v12, v248, 4, v14
    v_lshl_add_u32 v14, v248, 3, v14
    s_lshl_b32 s31, s3, 6
    v_add_u32 v11, s31, v14
    v_lshlrev_b32 v14, 3, v249
    v_add_u32 v13, 155136, v14
    s_mov_b32 s64, 0x41a00000
    s_mov_b32 s66, 0x3e0293ee
    s_mov_b32 s59, 0
    s_lshl_b32 s31, s3, 13
    s_sub_u32 s77, 262144, s31
    s_mov_b32 s35, 0x00020000
    s_mov_b32 s39, 0x00020000
    s_mov_b32 s43, 0x00020000
    s_mov_b32 s47, 0x00020000
    s_mov_b32 s99, 0x00020000
    s_lshr_b32 s82, s81, 1
    s_and_b32 s101, s82, 1
    s_waitcnt lgkmcnt(0)
    s_mov_b32 s96, s28
    s_mov_b32 s97, s29
    s_mov_b32 s98, 25165824
    s_or_b32 s31, s2, s3
    s_cmp_lg_u32 s31, 0
    s_cbranch_scc1 L_nm1
    s_memrealtime s[86:87]
    s_waitcnt lgkmcnt(0)
    s_or_b32 s31, s86, 1
    v_mov_b32 v14, 0
    v_mov_b32 v15, s31
    global_store_dword v14, v15, s[26:27] sc1
L_nm1:
    s_mov_b32 s93, 0
    v_lshrrev_b32 v14, 4, v0
    v_lshlrev_b32 v14, 13, v14
    v_and_b32 v15, 15, v0
    v_lshl_add_u32 v5, v15, 4, v14
    s_mov_b32 s0, s77
    s_mov_b32 s56, 0
    s_cmp_lg_u32 s101, 0
    s_cbranch_scc1 L_clsY
    s_mov_b32 s58, 2
    s_call_b64 s[94:95], L_jobA
    s_mov_b32 s56, s85
    s_mov_b32 s58, 0
    s_call_b64 s[94:95], L_jobB
    s_branch L_final
L_clsY:
    s_mov_b32 s58, 1
    s_call_b64 s[94:95], L_jobB
    s_mov_b32 s56, s85
    s_mov_b32 s58, 0
    s_call_b64 s[94:95], L_jobA
L_final:
    s_waitcnt vmcnt(0)
    s_barrier
    s_cmp_lg_u32 s3, 0
    s_cbranch_scc1 L_sg2
    s_call_b64 s[62:63], L_nonce
    v_mov_b32 v14, s85
    v_mov_b32 v15, s93
    s_mov_b64 exec, 1
    global_store_dword v14, v15, s[28:29] sc1
    s_mov_b64 exec, -1
L_sg2:
    s_lshl_b32 s51, s2, 2
    s_add_u32 s51, s51, s3
    s_cmp_ge_u32 s51, 768
    s_cbranch_scc1 L_attn_done
    s_mul_i32 s31, s51, 43691
    s_lshr_b32 s31, s31, 21
    s_and_b32 s31, s31, 1
    s_mul_i32 s53, s31, 768
    s_add_u32 s48, s51, s53
    s_call_b64 s[60:61], L_reduce
    s_sub_u32 s53, 768, s53
    s_add_u32 s48, s51, s53
    s_call_b64 s[60:61], L_reduce
L_attn_done:
L_attn_end:
    s_endpgm
L_jobA:
    s_and_b32 s84, s81, 1
    s_lshl_b32 s31, s84, 1
    s_lshr_b32 s53, s82, 1
    s_and_b32 s53, s53, 3
    s_lshl_b32 s83, s80, 2
    s_add_u32 s83, s83, s31
    s_mov_b32 s100, 256
    s_lshl_b32 s79, s83, 8
    s_lshl_b32 s78, s3, 6
    s_add_u32 s79, s79, s78
    s_add_u32 s40, s10, s79
    s_addc_u32 s41, s11, 0
    s_add_u32 s42, s100, 4186176
    s_mov_b32 s44, s4
    s_mov_b32 s45, s5
    s_mov_b32 s46, 786432
    s_mul_i32 s54, s82, 49152
    s_lshl_b32 s31, s80, 1
    s_add_u32 s31, s31, s84
    s_add_u32 s78, s82, 0
    s_lshl_b32 s85, s78, 8
    s_lshl_b32 s79, s31, 2
    s_add_u32 s85, s85, s79
    s_add_u32 s85, s85, 41943040
    s_lshl_b32 s78, s78, 4
    s_add_u32 s78, s78, s31
    s_lshl_b32 s78, s78, 2
    s_add_u32 s78, s78, s3
    s_mul_i32 s67, s78, 12288
    s_lshl_b32 s78, s3, 13
    s_lshl_b32 s31, s3, 2
    v_and_b32 v14, 15, v0
    v_xor_b32 v14, s31, v14
    v_lshlrev_b32 v14, 4, v14
    v_lshrrev_b32 v15, 4, v0
    v_lshl_add_u32 v1, v15, 11, v14
    s_mov_b32 s1, 32768
    s_sub_u32 s77, 262144, s78
    s_mov_b32 s0, s77
    s_lshl_b32 s79, s82, 3
    s_add_u32 s79, s79, s80
    s_lshl_b32 s79, s79, 18
    s_add_u32 s79, s79, s78
    s_add_u32 s68, s6, s79
    s_addc_u32 s69, s7, 0
    s_add_u32 s70, s8, s79
    s_addc_u32 s71, s9, 0
    s_mov_b32 s72, s68
    s_mov_b32 s73, s69
    s_mov_b32 s76, 0
    s_call_b64 s[60:61], L_qproj2
    s_call_b64 s[60:61], L_qfin0
    s_xor_b32 s31, s3, 0
    s_lshl_b32 s31, s31, 6
    v_add_u32 v248, s31, v12
    s_xor_b32 s31, s3, 1
    s_lshl_b32 s31, s31, 6
    v_add_u32 v249, s31, v12
    s_xor_b32 s31, s3, 2
    s_lshl_b32 s31, s31, 6
    v_add_u32 v250, s31, v12
    s_xor_b32 s31, s3, 3
    s_lshl_b32 s31, s31, 6
    v_add_u32 v251, s31, v12
    ds_read_b128 v[140:143], v248
    ds_read_b128 v[144:147], v249
    ds_read_b128 v[148:151], v250
    ds_read_b128 v[152:155], v251
    ds_read_b128 v[156:159], v248 offset:4608
    ds_read_b128 v[160:163], v249 offset:4608
    ds_read_b128 v[164:167], v250 offset:4608
    ds_read_b128 v[168:171], v251 offset:4608
    ds_read_b128 v[172:175], v248 offset:9216
    ds_read_b128 v[176:179], v249 offset:9216
    ds_read_b128 v[180:183], v250 offset:9216
    ds_read_b128 v[184:187], v251 offset:9216
    s_waitcnt lgkmcnt(0)
    s_cmp_lg_u32 s3, 0
    s_cbranch_scc1 L_sp3
    s_cmp_eq_u32 s56, 0
    s_cbranch_scc1 L_sp3
    s_call_b64 s[62:63], L_nonce
    v_mov_b32 v14, s56
    v_mov_b32 v15, s93
    s_mov_b64 exec, 1
    global_store_dword v14, v15, s[28:29] sc1
    s_mov_b64 exec, -1
L_sp3:
    s_mov_b32 s56, 0
    s_call_b64 s[60:61], L_qfin96
    s_xor_b32 s31, s3, 0
    s_lshl_b32 s31, s31, 6
    v_add_u32 v248, s31, v12
    s_xor_b32 s31, s3, 1
    s_lshl_b32 s31, s31, 6
    v_add_u32 v249, s31, v12
    s_xor_b32 s31, s3, 2
    s_lshl_b32 s31, s31, 6
    v_add_u32 v250, s31, v12
    s_xor_b32 s31, s3, 3
    s_lshl_b32 s31, s31, 6
    v_add_u32 v251, s31, v12
    ds_read_b128 v[188:191], v248
    ds_read_b128 v[192:195], v249
    ds_read_b128 v[196:199], v250
    ds_read_b128 v[200:203], v251
    ds_read_b128 v[204:207], v248 offset:4608
    ds_read_b128 v[208:211], v249 offset:4608
    ds_read_b128 v[212:215], v250 offset:4608
    ds_read_b128 v[216:219], v251 offset:4608
    ds_read_b128 v[220:223], v248 offset:9216
    ds_read_b128 v[224:227], v249 offset:9216
    ds_read_b128 v[228:231], v250 offset:9216
    ds_read_b128 v[232:235], v251 offset:9216
    s_waitcnt lgkmcnt(0)
    s_mov_b32 s32, s68
    s_mov_b32 s33, s69
    s_mov_b32 s34, s77
    s_mul_i32 s48, s1, 2
    s_mov_b32 s36, s70
    s_mov_b32 s37, s71
    s_mov_b32 s38, s77
    s_mul_i32 s52, s1, 0
    s_waitcnt vmcnt(8)
    ds_read_b128 a[192:195], v7
    ds_read_b128 a[196:199], v7 offset:64
    ds_read_b128 a[200:203], v7 offset:128
    ds_read_b128 a[204:207], v7 offset:192
    ds_read_b128 a[208:211], v7 offset:512
    ds_read_b128 a[212:215], v7 offset:576
    ds_read_b128 a[216:219], v7 offset:640
    ds_read_b128 a[220:223], v7 offset:704
    v_accvgpr_write_b32 a0, 0
    v_accvgpr_write_b32 a1, 0
    v_accvgpr_write_b32 a2, 0
    v_accvgpr_write_b32 a3, 0
    v_accvgpr_write_b32 a4, 0
    v_accvgpr_write_b32 a5, 0
    v_accvgpr_write_b32 a6, 0
    v_accvgpr_write_b32 a7, 0
    v_accvgpr_write_b32 a8, 0
    v_accvgpr_write_b32 a9, 0
    v_accvgpr_write_b32 a10, 0
    v_accvgpr_write_b32 a11, 0
    v_accvgpr_write_b32 a12, 0
    v_accvgpr_write_b32 a13, 0
    v_accvgpr_write_b32 a14, 0
    v_accvgpr_write_b32 a15, 0
    v_accvgpr_write_b32 a16, 0
    v_accvgpr_write_b32 a17, 0
    v_accvgpr_write_b32 a18, 0
    v_accvgpr_write_b32 a19, 0
    v_accvgpr_write_b32 a20, 0
    v_accvgpr_write_b32 a21, 0
    v_accvgpr_write_b32 a22, 0
    v_accvgpr_write_b32 a23, 0
    v_accvgpr_write_b32 a24, 0
    v_accvgpr_write_b32 a25, 0
    v_accvgpr_write_b32 a26, 0
    v_accvgpr_write_b32 a27, 0
    v_accvgpr_write_b32 a28, 0
    v_accvgpr_write_b32 a29, 0
    v_accvgpr_write_b32 a30, 0
    v_accvgpr_write_b32 a31, 0
    v_accvgpr_write_b32 a32, 0
    v_accvgpr_write_b32 a33, 0
    v_accvgpr_write_b32 a34, 0
    v_accvgpr_write_b32 a35, 0
    v_accvgpr_write_b32 a36, 0
    v_accvgpr_write_b32 a37, 0
    v_accvgpr_write_b32 a38, 0
    v_accvgpr_write_b32 a39, 0
    v_accvgpr_write_b32 a40, 0
    v_accvgpr_write_b32 a41, 0
    v_accvgpr_write_b32 a42, 0
    v_accvgpr_write_b32 a43, 0
    v_accvgpr_write_b32 a44, 0
    v_accvgpr_write_b32 a45, 0
    v_accvgpr_write_b32 a46, 0
    v_accvgpr_write_b32 a47, 0
    s_waitcnt lgkmcnt(0)
    v_mfma_f32_16x16x32_bf16 v[16:19], a[192:195], v[140:143], 0
    s_add_u32 m0, s30, 0
    s_nop 0
    buffer_load_dwordx4 v1, s[36:39], s52 offen nt lds
    s_add_u32 m0, m0, 800
    s_nop 0
    buffer_load_dwordx4 v1, s[36:39], s52 offen offset:256 nt lds
    s_add_u32 m0, m0, 800
    v_mfma_f32_16x16x32_bf16 v[16:19], a[196:199], v[144:147], v[16:19]
    buffer_load_dwordx4 v1, s[36:39], s52 offen offset:512 nt lds
    s_add_u32 m0, m0, 800
    s_nop 0
    buffer_load_dwordx4 v1, s[36:39], s52 offen offset:768 nt lds
    s_add_u32 m0, m0, 800
    v_mfma_f32_16x16x32_bf16 v[16:19], a[200:203], v[148:151], v[16:19]
    buffer_load_dwordx4 v1, s[36:39], s52 offen offset:1024 nt lds
    s_add_u32 m0, m0, 800
    s_nop 0
    buffer_load_dwordx4 v1, s[36:39], s52 offen offset:1280 nt lds
    s_add_u32 m0, m0, 800
    s_nop 0
    buffer_load_dwordx4 v1, s[36:39], s52 offen offset:1536 nt lds
    v_mfma_f32_16x16x32_bf16 v[16:19], a[204:207], v[152:155], v[16:19]
    s_add_u32 m0, m0, 800
    s_nop 0
    buffer_load_dwordx4 v1, s[36:39], s52 offen offset:1792 nt lds
    s_add_u32 s52, s52, s1
    v_accvgpr_write_b32 a48, 0
    v_mfma_f32_16x16x32_bf16 v[20:23], a[208:211], v[140:143], 0
    v_accvgpr_write_b32 a49, 0
    v_accvgpr_write_b32 a50, 0
    v_accvgpr_write_b32 a51, 0
    v_accvgpr_write_b32 a52, 0
    v_accvgpr_write_b32 a53, 0
    v_mfma_f32_16x16x32_bf16 v[20:23], a[212:215], v[144:147], v[20:23]
    v_accvgpr_write_b32 a54, 0
    v_accvgpr_write_b32 a55, 0
    v_accvgpr_write_b32 a56, 0
    v_accvgpr_write_b32 a57, 0
    v_mfma_f32_16x16x32_bf16 v[20:23], a[216:219], v[148:151], v[20:23]
    v_accvgpr_write_b32 a58, 0
    v_accvgpr_write_b32 a59, 0
    v_accvgpr_write_b32 a60, 0
    v_accvgpr_write_b32 a61, 0
    v_accvgpr_write_b32 a62, 0
    v_mfma_f32_16x16x32_bf16 v[20:23], a[220:223], v[152:155], v[20:23]
    v_accvgpr_write_b32 a63, 0
    v_accvgpr_write_b32 a64, 0
    v_accvgpr_write_b32 a65, 0
    v_accvgpr_write_b32 a66, 0
    v_mfma_f32_16x16x32_bf16 v[24:27], a[192:195], v[156:159], 0
    v_accvgpr_write_b32 a67, 0
    v_accvgpr_write_b32 a68, 0
    v_accvgpr_write_b32 a69, 0
    v_accvgpr_write_b32 a70, 0
    v_accvgpr_write_b32 a71, 0
    v_mfma_f32_16x16x32_bf16 v[24:27], a[196:199], v[160:163], v[24:27]
    v_accvgpr_write_b32 a72, 0
    v_accvgpr_write_b32 a73, 0
    v_accvgpr_write_b32 a74, 0
    v_accvgpr_write_b32 a75, 0
    v_mfma_f32_16x16x32_bf16 v[24:27], a[200:203], v[164:167], v[24:27]
    v_accvgpr_write_b32 a76, 0
    v_accvgpr_write_b32 a77, 0
    v_accvgpr_write_b32 a78, 0
    v_accvgpr_write_b32 a79, 0
    v_accvgpr_write_b32 a80, 0
    v_mfma_f32_16x16x32_bf16 v[24:27], a[204:207], v[168:171], v[24:27]
    v_accvgpr_write_b32 a81, 0
    v_accvgpr_write_b32 a82, 0
    v_accvgpr_write_b32 a83, 0
    v_accvgpr_write_b32 a84, 0
    v_mfma_f32_16x16x32_bf16 v[28:31], a[208:211], v[156:159], 0
    v_accvgpr_write_b32 a85, 0
    v_accvgpr_write_b32 a86, 0
    v_accvgpr_write_b32 a87, 0
    v_accvgpr_write_b32 a88, 0
    v_mfma_f32_16x16x32_bf16 v[28:31], a[212:215], v[160:163], v[28:31]
    v_accvgpr_write_b32 a89, 0
    v_accvgpr_write_b32 a90, 0
    v_accvgpr_write_b32 a91, 0
    v_accvgpr_write_b32 a92, 0
    v_accvgpr_write_b32 a93, 0
    v_mfma_f32_16x16x32_bf16 v[28:31], a[216:219], v[164:167], v[28:31]
    v_accvgpr_write_b32 a94, 0
    v_accvgpr_write_b32 a95, 0
    v_accvgpr_write_b32 a96, 0
    v_accvgpr_write_b32 a97, 0
    v_mfma_f32_16x16x32_bf16 v[28:31], a[220:223], v[168:171], v[28:31]
    v_accvgpr_write_b32 a98, 0
    v_accvgpr_write_b32 a99, 0
    v_accvgpr_write_b32 a100, 0
    v_accvgpr_write_b32 a101, 0
    v_accvgpr_write_b32 a102, 0
    v_mfma_f32_16x16x32_bf16 v[32:35], a[192:195], v[172:175], 0
    v_accvgpr_write_b32 a103, 0
    v_accvgpr_write_b32 a104, 0
    v_accvgpr_write_b32 a105, 0
    v_accvgpr_write_b32 a106, 0
    v_mfma_f32_16x16x32_bf16 v[32:35], a[196:199], v[176:179], v[32:35]
    v_accvgpr_write_b32 a107, 0
    v_accvgpr_write_b32 a108, 0
    v_accvgpr_write_b32 a109, 0
    v_accvgpr_write_b32 a110, 0
    v_accvgpr_write_b32 a111, 0
    v_mfma_f32_16x16x32_bf16 v[32:35], a[200:203], v[180:183], v[32:35]
    v_accvgpr_write_b32 a112, 0
    v_accvgpr_write_b32 a113, 0
    v_accvgpr_write_b32 a114, 0
    v_accvgpr_write_b32 a115, 0
    v_mfma_f32_16x16x32_bf16 v[32:35], a[204:207], v[184:187], v[32:35]
    v_accvgpr_write_b32 a116, 0
    v_accvgpr_write_b32 a117, 0
    v_accvgpr_write_b32 a118, 0
    v_accvgpr_write_b32 a119, 0
    v_accvgpr_write_b32 a120, 0
    v_mfma_f32_16x16x32_bf16 v[36:39], a[208:211], v[172:175], 0
    v_accvgpr_write_b32 a121, 0
    v_accvgpr_write_b32 a122, 0
    v_accvgpr_write_b32 a123, 0
    v_accvgpr_write_b32 a124, 0
    v_mfma_f32_16x16x32_bf16 v[36:39], a[212:215], v[176:179], v[36:39]
    v_accvgpr_write_b32 a125, 0
    v_accvgpr_write_b32 a126, 0
    v_accvgpr_write_b32 a127, 0
    v_accvgpr_write_b32 a128, 0
    v_accvgpr_write_b32 a129, 0
    v_mfma_f32_16x16x32_bf16 v[36:39], a[216:219], v[180:183], v[36:39]
    v_accvgpr_write_b32 a130, 0
    v_accvgpr_write_b32 a131, 0
    v_accvgpr_write_b32 a132, 0
    v_accvgpr_write_b32 a133, 0
    v_mfma_f32_16x16x32_bf16 v[36:39], a[220:223], v[184:187], v[36:39]
    v_accvgpr_write_b32 a134, 0
    v_accvgpr_write_b32 a135, 0
    v_accvgpr_write_b32 a136, 0
    v_accvgpr_write_b32 a137, 0
    v_mfma_f32_16x16x32_bf16 v[40:43], a[192:195], v[188:191], 0
    v_accvgpr_write_b32 a138, 0
    v_accvgpr_write_b32 a139, 0
    v_accvgpr_write_b32 a140, 0
    v_accvgpr_write_b32 a141, 0
    v_accvgpr_write_b32 a142, 0
    v_mfma_f32_16x16x32_bf16 v[40:43], a[196:199], v[192:195], v[40:43]
    v_accvgpr_write_b32 a143, 0
    v_accvgpr_write_b32 a144, 0
    v_accvgpr_write_b32 a145, 0
    v_accvgpr_write_b32 a146, 0
    v_mfma_f32_16x16x32_bf16 v[40:43], a[200:203], v[196:199], v[40:43]
    v_accvgpr_write_b32 a147, 0
    v_accvgpr_write_b32 a148, 0
    v_accvgpr_write_b32 a149, 0
    v_accvgpr_write_b32 a150, 0
    v_accvgpr_write_b32 a151, 0
    v_mfma_f32_16x16x32_bf16 v[40:43], a[204:207], v[200:203], v[40:43]
    v_accvgpr_write_b32 a152, 0
    v_accvgpr_write_b32 a153, 0
    v_accvgpr_write_b32 a154, 0
    v_accvgpr_write_b32 a155, 0
    v_mfma_f32_16x16x32_bf16 v[44:47], a[208:211], v[188:191], 0
    v_accvgpr_write_b32 a156, 0
    v_accvgpr_write_b32 a157, 0
    v_accvgpr_write_b32 a158, 0
    v_accvgpr_write_b32 a159, 0
    v_accvgpr_write_b32 a160, 0
    v_mfma_f32_16x16x32_bf16 v[44:47], a[212:215], v[192:195], v[44:47]
    v_accvgpr_write_b32 a161, 0
    v_accvgpr_write_b32 a162, 0
    v_accvgpr_write_b32 a163, 0
    v_accvgpr_write_b32 a164, 0
    v_mfma_f32_16x16x32_bf16 v[44:47], a[216:219], v[196:199], v[44:47]
    v_accvgpr_write_b32 a165, 0
    v_accvgpr_write_b32 a166, 0
    v_accvgpr_write_b32 a167, 0
    v_accvgpr_write_b32 a168, 0
    v_accvgpr_write_b32 a169, 0
    v_mfma_f32_16x16x32_bf16 v[44:47], a[220:223], v[200:203], v[44:47]
    v_accvgpr_write_b32 a170, 0
    v_accvgpr_write_b32 a171, 0
    v_accvgpr_write_b32 a172, 0
    v_accvgpr_write_b32 a173, 0
    v_mfma_f32_16x16x32_bf16 v[48:51], a[192:195], v[204:207], 0
    v_accvgpr_write_b32 a174, 0
    v_accvgpr_write_b32 a175, 0
    v_accvgpr_write_b32 a176, 0
    v_accvgpr_write_b32 a177, 0
    v_accvgpr_write_b32 a178, 0
    v_mfma_f32_16x16x32_bf16 v[48:51], a[196:199], v[208:211], v[48:51]
    v_accvgpr_write_b32 a179, 0
    v_accvgpr_write_b32 a180, 0
    v_accvgpr_write_b32 a181, 0
    v_accvgpr_write_b32 a182, 0
    v_mfma_f32_16x16x32_bf16 v[48:51], a[200:203], v[212:215], v[48:51]
    v_accvgpr_write_b32 a183, 0
    v_accvgpr_write_b32 a184, 0
    v_accvgpr_write_b32 a185, 0
    v_accvgpr_write_b32 a186, 0
    v_accvgpr_write_b32 a187, 0
    v_mfma_f32_16x16x32_bf16 v[48:51], a[204:207], v[216:219], v[48:51]
    v_accvgpr_write_b32 a188, 0
    v_accvgpr_write_b32 a189, 0
    v_accvgpr_write_b32 a190, 0
    v_accvgpr_write_b32 a191, 0
    v_mfma_f32_16x16x32_bf16 v[52:55], a[208:211], v[204:207], 0
    v_mov_b32 v112, 0
    v_mov_b32 v88, 0
    v_mov_b32 v113, 0
    v_mov_b32 v89, 0
    v_mfma_f32_16x16x32_bf16 v[52:55], a[212:215], v[208:211], v[52:55]
    v_mov_b32 v114, 0
    v_mov_b32 v90, 0
    v_mov_b32 v115, 0
    v_mov_b32 v91, 0
    v_mov_b32 v116, 0
    v_mfma_f32_16x16x32_bf16 v[52:55], a[216:219], v[212:215], v[52:55]
    v_mov_b32 v92, 0
    v_mov_b32 v117, 0
    v_mov_b32 v93, 0
    v_mov_b32 v118, 0
    v_mfma_f32_16x16x32_bf16 v[52:55], a[220:223], v[216:219], v[52:55]
    v_mov_b32 v94, 0
    v_mov_b32 v119, 0
    v_mov_b32 v95, 0
    v_mov_b32 v120, 0
    v_mov_b32 v96, 0
    v_mfma_f32_16x16x32_bf16 v[56:59], a[192:195], v[220:223], 0
    v_mov_b32 v121, 0
    v_mov_b32 v97, 0
    v_mov_b32 v122, 0
    v_mov_b32 v98, 0
    v_mfma_f32_16x16x32_bf16 v[56:59], a[196:199], v[224:227], v[56:59]
    v_mov_b32 v123, 0
    v_mov_b32 v99, 0
    v_mov_b32 v124, 0
    v_mov_b32 v100, 0
    v_mov_b32 v125, 0
    v_mfma_f32_16x16x32_bf16 v[56:59], a[200:203], v[228:231], v[56:59]
    v_mov_b32 v101, 0
    v_mov_b32 v126, 0
    v_mov_b32 v102, 0
    v_mov_b32 v127, 0
    v_mfma_f32_16x16x32_bf16 v[56:59], a[204:207], v[232:235], v[56:59]
    v_mov_b32 v103, 0
    v_mov_b32 v128, 0
    v_mov_b32 v104, 0
    v_mov_b32 v129, 0
    v_mov_b32 v105, 0
    v_mfma_f32_16x16x32_bf16 v[60:63], a[208:211], v[220:223], 0
    v_mov_b32 v130, 0
    v_mov_b32 v106, 0
    v_mov_b32 v131, 0
    v_mov_b32 v107, 0
    v_mfma_f32_16x16x32_bf16 v[60:63], a[212:215], v[224:227], v[60:63]
    v_mov_b32 v132, 0
    v_mov_b32 v108, 0
    v_mov_b32 v133, 0
    v_mov_b32 v109, 0
    v_mov_b32 v134, 0
    v_mfma_f32_16x16x32_bf16 v[60:63], a[216:219], v[228:231], v[60:63]
    v_mov_b32 v110, 0
    v_mov_b32 v135, 0
    v_mov_b32 v111, 0
    v_mov_b32 v136, 0x3f803f80
    v_mfma_f32_16x16x32_bf16 v[60:63], a[220:223], v[232:235], v[60:63]
    v_mov_b32 v137, 0x3f803f80
    v_mov_b32 v138, 0x3f803f80
    v_mov_b32 v139, 0x3f803f80
    s_mov_b32 s65, 0xff800000
    s_waitcnt vmcnt(8)
    ds_read_b128 a[192:195], v7 offset:8448
    ds_read_b128 a[196:199], v7 offset:8512
    ds_read_b128 a[200:203], v7 offset:8576
    ds_read_b128 a[204:207], v7 offset:8640
    ds_read_b128 a[208:211], v7 offset:8960
    ds_read_b128 a[212:215], v7 offset:9024
    ds_read_b128 a[216:219], v7 offset:9088
    ds_read_b128 a[220:223], v7 offset:9152
    s_call_b64 s[62:63], L_rare1_6
    s_mov_b32 s65, 0
    s_mov_b32 s59, 0
    v_exp_f32 v16, v16
    v_exp_f32 v17, v17
    v_exp_f32 v18, v18
    v_exp_f32 v19, v19
    v_exp_f32 v20, v20
    v_exp_f32 v21, v21
    v_exp_f32 v22, v22
    s_waitcnt lgkmcnt(0)
    v_exp_f32 v23, v23
    v_exp_f32 v24, v24
    s_add_u32 m0, s30, 8448
    v_exp_f32 v25, v25
    v_exp_f32 v26, v26
    v_exp_f32 v27, v27
    buffer_load_dwordx4 v1, s[32:35], s48 offen nt lds
    v_exp_f32 v28, v28
    v_exp_f32 v29, v29
    s_add_u32 m0, m0, 800
    v_exp_f32 v30, v30
    v_exp_f32 v31, v31
    v_exp_f32 v32, v32
    buffer_load_dwordx4 v1, s[32:35], s48 offen offset:256 nt lds
    v_exp_f32 v33, v33
    v_exp_f32 v34, v34
    s_add_u32 m0, m0, 800
    v_exp_f32 v35, v35
    v_exp_f32 v36, v36
    v_exp_f32 v37, v37
    buffer_load_dwordx4 v1, s[32:35], s48 offen offset:512 nt lds
    v_exp_f32 v38, v38
    v_exp_f32 v39, v39
    s_add_u32 m0, m0, 800
    v_exp_f32 v40, v40
    v_exp_f32 v41, v41
    buffer_load_dwordx4 v1, s[32:35], s48 offen offset:768 nt lds
    v_exp_f32 v42, v42
    v_exp_f32 v43, v43
    v_exp_f32 v44, v44
    s_add_u32 m0, m0, 800
    v_exp_f32 v45, v45
    v_exp_f32 v46, v46
    buffer_load_dwordx4 v1, s[32:35], s48 offen offset:1024 nt lds
    v_exp_f32 v47, v47
    v_exp_f32 v48, v48
    v_exp_f32 v49, v49
    s_add_u32 m0, m0, 800
    v_exp_f32 v50, v50
    v_exp_f32 v51, v51
    buffer_load_dwordx4 v1, s[32:35], s48 offen offset:1280 nt lds
    v_exp_f32 v52, v52
    v_exp_f32 v53, v53
    v_exp_f32 v54, v54
    s_add_u32 m0, m0, 800
    v_exp_f32 v55, v55
    v_exp_f32 v56, v56
    buffer_load_dwordx4 v1, s[32:35], s48 offen offset:1536 nt lds
    v_exp_f32 v57, v57
    v_exp_f32 v58, v58
    v_exp_f32 v59, v59
    s_add_u32 m0, m0, 800
    v_exp_f32 v60, v60
    v_exp_f32 v61, v61
    buffer_load_dwordx4 v1, s[32:35], s48 offen offset:1792 nt lds
    v_exp_f32 v62, v62
    v_exp_f32 v63, v63
    s_add_u32 s48, s48, s1
    v_cvt_pk_bf16_f32 v64, v16, v17
    v_cvt_pk_bf16_f32 v65, v18, v19
    v_cvt_pk_bf16_f32 v66, v20, v21
    v_cvt_pk_bf16_f32 v67, v22, v23
    v_cvt_pk_bf16_f32 v68, v24, v25
    v_cvt_pk_bf16_f32 v69, v26, v27
    v_cvt_pk_bf16_f32 v70, v28, v29
    v_cvt_pk_bf16_f32 v71, v30, v31
    v_cvt_pk_bf16_f32 v72, v32, v33
    v_cvt_pk_bf16_f32 v73, v34, v35
    v_cvt_pk_bf16_f32 v74, v36, v37
    v_cvt_pk_bf16_f32 v75, v38, v39
    v_cvt_pk_bf16_f32 v76, v40, v41
    v_cvt_pk_bf16_f32 v77, v42, v43
    v_cvt_pk_bf16_f32 v78, v44, v45
    v_cvt_pk_bf16_f32 v79, v46, v47
    v_cvt_pk_bf16_f32 v80, v48, v49
    v_cvt_pk_bf16_f32 v81, v50, v51
    v_cvt_pk_bf16_f32 v82, v52, v53
    v_cvt_pk_bf16_f32 v83, v54, v55
    v_cvt_pk_bf16_f32 v84, v56, v57
    v_cvt_pk_bf16_f32 v85, v58, v59
    v_cvt_pk_bf16_f32 v86, v60, v61
    v_cvt_pk_bf16_f32 v87, v62, v63
    v_mfma_f32_16x16x32_bf16 v[16:19], a[192:195], v[140:143], v[88:91]
    s_waitcnt vmcnt(8)
    v_mfma_f32_16x16x32_bf16 v[16:19], a[196:199], v[144:147], v[16:19]
    ds_read_b64_tr_b16 a[224:225], v8
    v_mfma_f32_16x16x32_bf16 v[16:19], a[200:203], v[148:151], v[16:19]
    ds_read_b64_tr_b16 a[226:227], v8 offset:512
    v_mfma_f32_16x16x32_bf16 v[16:19], a[204:207], v[152:155], v[16:19]
    v_mfma_f32_16x16x32_bf16 v[20:23], a[208:211], v[140:143], v[88:91]
    ds_read_b64_tr_b16 a[228:229], v8 offset:32
    v_mfma_f32_16x16x32_bf16 v[20:23], a[212:215], v[144:147], v[20:23]
    ds_read_b64_tr_b16 a[230:231], v8 offset:544
    v_mfma_f32_16x16x32_bf16 v[20:23], a[216:219], v[148:151], v[20:23]
    ds_read_b64_tr_b16 a[232:233], v8 offset:64
    v_mfma_f32_16x16x32_bf16 v[20:23], a[220:223], v[152:155], v[20:23]
    v_mfma_f32_16x16x32_bf16 v[24:27], a[192:195], v[156:159], v[92:95]
    ds_read_b64_tr_b16 a[234:235], v8 offset:576
    v_mfma_f32_16x16x32_bf16 v[24:27], a[196:199], v[160:163], v[24:27]
    ds_read_b64_tr_b16 a[236:237], v8 offset:96
    v_mfma_f32_16x16x32_bf16 v[24:27], a[200:203], v[164:167], v[24:27]
    ds_read_b64_tr_b16 a[238:239], v8 offset:608
    v_mfma_f32_16x16x32_bf16 v[24:27], a[204:207], v[168:171], v[24:27]
    v_mfma_f32_16x16x32_bf16 v[28:31], a[208:211], v[156:159], v[92:95]
    ds_read_b64_tr_b16 a[240:241], v8 offset:128
    v_mfma_f32_16x16x32_bf16 v[28:31], a[212:215], v[160:163], v[28:31]
    ds_read_b64_tr_b16 a[242:243], v8 offset:640
    v_mfma_f32_16x16x32_bf16 v[28:31], a[216:219], v[164:167], v[28:31]
    ds_read_b64_tr_b16 a[244:245], v8 offset:160
    v_mfma_f32_16x16x32_bf16 v[28:31], a[220:223], v[168:171], v[28:31]
    v_mfma_f32_16x16x32_bf16 v[32:35], a[192:195], v[172:175], v[96:99]
    ds_read_b64_tr_b16 a[246:247], v8 offset:672
    v_mfma_f32_16x16x32_bf16 v[32:35], a[196:199], v[176:179], v[32:35]
    ds_read_b64_tr_b16 a[248:249], v8 offset:192
    v_mfma_f32_16x16x32_bf16 v[32:35], a[200:203], v[180:183], v[32:35]
    ds_read_b64_tr_b16 a[250:251], v8 offset:704
    v_mfma_f32_16x16x32_bf16 v[32:35], a[204:207], v[184:187], v[32:35]
    v_mfma_f32_16x16x32_bf16 v[36:39], a[208:211], v[172:175], v[96:99]
    ds_read_b64_tr_b16 a[252:253], v8 offset:224
    v_mfma_f32_16x16x32_bf16 v[36:39], a[212:215], v[176:179], v[36:39]
    ds_read_b64_tr_b16 a[254:255], v8 offset:736
    v_mfma_f32_16x16x32_bf16 v[36:39], a[216:219], v[180:183], v[36:39]
    s_waitcnt lgkmcnt(0)
    v_mfma_f32_16x16x32_bf16 v[36:39], a[220:223], v[184:187], v[36:39]
    v_mfma_f32_16x16x32_bf16 v[40:43], a[192:195], v[188:191], v[100:103]
    s_add_u32 m0, s30, 0
    v_mfma_f32_16x16x32_bf16 v[40:43], a[196:199], v[192:195], v[40:43]
    buffer_load_dwordx4 v1, s[36:39], s52 offen nt lds
    v_mfma_f32_16x16x32_bf16 v[40:43], a[200:203], v[196:199], v[40:43]
    s_add_u32 m0, m0, 800
    v_mfma_f32_16x16x32_bf16 v[40:43], a[204:207], v[200:203], v[40:43]
    v_mfma_f32_16x16x32_bf16 v[44:47], a[208:211], v[188:191], v[100:103]
    buffer_load_dwordx4 v1, s[36:39], s52 offen offset:256 nt lds
    v_mfma_f32_16x16x32_bf16 v[44:47], a[212:215], v[192:195], v[44:47]
    s_add_u32 m0, m0, 800
    v_mfma_f32_16x16x32_bf16 v[44:47], a[216:219], v[196:199], v[44:47]
    buffer_load_dwordx4 v1, s[36:39], s52 offen offset:512 nt lds
    v_mfma_f32_16x16x32_bf16 v[44:47], a[220:223], v[200:203], v[44:47]
    v_mfma_f32_16x16x32_bf16 v[48:51], a[192:195], v[204:207], v[104:107]
    s_add_u32 m0, m0, 800
    v_mfma_f32_16x16x32_bf16 v[48:51], a[196:199], v[208:211], v[48:51]
    buffer_load_dwordx4 v1, s[36:39], s52 offen offset:768 nt lds
    v_mfma_f32_16x16x32_bf16 v[48:51], a[200:203], v[212:215], v[48:51]
    s_add_u32 m0, m0, 800
    v_mfma_f32_16x16x32_bf16 v[48:51], a[204:207], v[216:219], v[48:51]
    v_mfma_f32_16x16x32_bf16 v[52:55], a[208:211], v[204:207], v[104:107]
    buffer_load_dwordx4 v1, s[36:39], s52 offen offset:1024 nt lds
    v_mfma_f32_16x16x32_bf16 v[52:55], a[212:215], v[208:211], v[52:55]
    s_add_u32 m0, m0, 800
    v_mfma_f32_16x16x32_bf16 v[52:55], a[216:219], v[212:215], v[52:55]
    buffer_load_dwordx4 v1, s[36:39], s52 offen offset:1280 nt lds
    v_mfma_f32_16x16x32_bf16 v[52:55], a[220:223], v[216:219], v[52:55]
    v_mfma_f32_16x16x32_bf16 v[56:59], a[192:195], v[220:223], v[108:111]
    s_add_u32 m0, m0, 800
    v_mfma_f32_16x16x32_bf16 v[56:59], a[196:199], v[224:227], v[56:59]
    buffer_load_dwordx4 v1, s[36:39], s52 offen offset:1536 nt lds
    v_mfma_f32_16x16x32_bf16 v[56:59], a[200:203], v[228:231], v[56:59]
    s_add_u32 m0, m0, 800
    v_mfma_f32_16x16x32_bf16 v[56:59], a[204:207], v[232:235], v[56:59]
    v_mfma_f32_16x16x32_bf16 v[60:63], a[208:211], v[220:223], v[108:111]
    buffer_load_dwordx4 v1, s[36:39], s52 offen offset:1792 nt lds
    v_mfma_f32_16x16x32_bf16 v[60:63], a[212:215], v[224:227], v[60:63]
    s_add_u32 s52, s52, s1
    v_mfma_f32_16x16x32_bf16 v[60:63], a[216:219], v[228:231], v[60:63]
    s_mov_b32 s57, 1
    v_mfma_f32_16x16x32_bf16 v[60:63], a[220:223], v[232:235], v[60:63]
L_loop_A:
    v_mfma_f32_16x16x32_bf16 a[0:3], a[224:227], v[64:67], a[0:3]
    s_waitcnt vmcnt(8)
    ds_read_b128 a[192:195], v7 offset:8448
    ds_read_b128 a[196:199], v7 offset:8512
    v_mfma_f32_16x16x32_bf16 a[4:7], a[228:231], v[64:67], a[4:7]
    ds_read_b128 a[200:203], v7 offset:8576
    ds_read_b128 a[204:207], v7 offset:8640
    v_mfma_f32_16x16x32_bf16 a[8:11], a[232:235], v[64:67], a[8:11]
    ds_read_b128 a[208:211], v7 offset:8960
    ds_read_b128 a[212:215], v7 offset:9024
    v_mfma_f32_16x16x32_bf16 a[12:15], a[236:239], v[64:67], a[12:15]
    ds_read_b128 a[216:219], v7 offset:9088
    ds_read_b128 a[220:223], v7 offset:9152
    v_max3_f32 v246, v16, v17, v18
    v_mfma_f32_16x16x32_bf16 a[16:19], a[240:243], v[64:67], a[16:19]
    v_max3_f32 v246, v246, v19, v20
    v_max3_f32 v246, v246, v21, v22
    v_mfma_f32_16x16x32_bf16 a[20:23], a[244:247], v[64:67], a[20:23]
    v_max3_f32 v246, v246, v23, v24
    v_max3_f32 v246, v246, v25, v26
    v_mfma_f32_16x16x32_bf16 a[24:27], a[248:251], v[64:67], a[24:27]
    v_max3_f32 v246, v246, v27, v28
    v_max3_f32 v246, v246, v29, v30
    v_max3_f32 v246, v246, v31, v32
    v_mfma_f32_16x16x32_bf16 a[28:31], a[252:255], v[64:67], a[28:31]
    v_max3_f32 v246, v246, v33, v34
    v_max3_f32 v246, v246, v35, v36
    v_mfma_f32_16x16x32_bf16 v[112:115], v[136:139], v[64:67], v[112:115]
    v_max3_f32 v246, v246, v37, v38
    v_max_f32 v246, v246, v39
    v_mfma_f32_16x16x32_bf16 a[32:35], a[224:227], v[68:71], a[32:35]
    v_max3_f32 v247, v40, v41, v42
    v_max3_f32 v247, v247, v43, v44
    v_max3_f32 v247, v247, v45, v46
    v_mfma_f32_16x16x32_bf16 a[36:39], a[228:231], v[68:71], a[36:39]
    v_max3_f32 v247, v247, v47, v48
    v_max3_f32 v247, v247, v49, v50
    v_mfma_f32_16x16x32_bf16 a[40:43], a[232:235], v[68:71], a[40:43]
    v_max3_f32 v247, v247, v51, v52
    v_max3_f32 v247, v247, v53, v54
    v_mfma_f32_16x16x32_bf16 a[44:47], a[236:239], v[68:71], a[44:47]
    v_max3_f32 v247, v247, v55, v56
    v_max3_f32 v247, v247, v57, v58
    v_max3_f32 v247, v247, v59, v60
    v_mfma_f32_16x16x32_bf16 a[48:51], a[240:243], v[68:71], a[48:51]
    v_max3_f32 v247, v247, v61, v62
    v_max_f32 v247, v247, v63
    v_mfma_f32_16x16x32_bf16 a[52:55], a[244:247], v[68:71], a[52:55]
    v_max_f32 v246, v246, v247
    v_cmp_lt_f32 vcc, s64, v246
    v_mfma_f32_16x16x32_bf16 a[56:59], a[248:251], v[68:71], a[56:59]
    s_cbranch_vccz L_sk4
    s_call_b64 s[62:63], L_rare1_6
L_sk4:
    v_exp_f32 v16, v16
    v_exp_f32 v17, v17
    v_mfma_f32_16x16x32_bf16 a[60:63], a[252:255], v[68:71], a[60:63]
    v_exp_f32 v18, v18
    v_exp_f32 v19, v19
    v_mfma_f32_16x16x32_bf16 v[116:119], v[136:139], v[68:71], v[116:119]
    v_exp_f32 v20, v20
    v_exp_f32 v21, v21
    v_mfma_f32_16x16x32_bf16 a[64:67], a[224:227], v[72:75], a[64:67]
    v_exp_f32 v22, v22
    s_waitcnt lgkmcnt(0)
    v_exp_f32 v23, v23
    v_mfma_f32_16x16x32_bf16 a[68:71], a[228:231], v[72:75], a[68:71]
    v_exp_f32 v24, v24
    s_add_u32 m0, s30, 8448
    v_mfma_f32_16x16x32_bf16 a[72:75], a[232:235], v[72:75], a[72:75]
    v_exp_f32 v25, v25
    v_exp_f32 v26, v26
    v_mfma_f32_16x16x32_bf16 a[76:79], a[236:239], v[72:75], a[76:79]
    v_exp_f32 v27, v27
    buffer_load_dwordx4 v1, s[32:35], s48 offen nt lds
    v_exp_f32 v28, v28
    v_mfma_f32_16x16x32_bf16 a[80:83], a[240:243], v[72:75], a[80:83]
    v_exp_f32 v29, v29
    s_add_u32 m0, m0, 800
    v_mfma_f32_16x16x32_bf16 a[84:87], a[244:247], v[72:75], a[84:87]
    v_exp_f32 v30, v30
    v_exp_f32 v31, v31
    v_mfma_f32_16x16x32_bf16 a[88:91], a[248:251], v[72:75], a[88:91]
    v_exp_f32 v32, v32
    buffer_load_dwordx4 v1, s[32:35], s48 offen offset:256 nt lds
    v_exp_f32 v33, v33
    v_mfma_f32_16x16x32_bf16 a[92:95], a[252:255], v[72:75], a[92:95]
    v_exp_f32 v34, v34
    s_add_u32 m0, m0, 800
    v_mfma_f32_16x16x32_bf16 v[120:123], v[136:139], v[72:75], v[120:123]
    v_exp_f32 v35, v35
    v_exp_f32 v36, v36
    v_mfma_f32_16x16x32_bf16 a[96:99], a[224:227], v[76:79], a[96:99]
    v_exp_f32 v37, v37
    buffer_load_dwordx4 v1, s[32:35], s48 offen offset:512 nt lds
    v_exp_f32 v38, v38
    v_mfma_f32_16x16x32_bf16 a[100:103], a[228:231], v[76:79], a[100:103]
    v_exp_f32 v39, v39
    s_add_u32 m0, m0, 800
    v_mfma_f32_16x16x32_bf16 a[104:107], a[232:235], v[76:79], a[104:107]
    v_exp_f32 v40, v40
    v_exp_f32 v41, v41
    v_mfma_f32_16x16x32_bf16 a[108:111], a[236:239], v[76:79], a[108:111]
    buffer_load_dwordx4 v1, s[32:35], s48 offen offset:768 nt lds
    v_exp_f32 v42, v42
    v_exp_f32 v43, v43
    v_mfma_f32_16x16x32_bf16 a[112:115], a[240:243], v[76:79], a[112:115]
    v_exp_f32 v44, v44
    s_add_u32 m0, m0, 800
    v_mfma_f32_16x16x32_bf16 a[116:119], a[244:247], v[76:79], a[116:119]
    v_exp_f32 v45, v45
    v_exp_f32 v46, v46
    v_mfma_f32_16x16x32_bf16 a[120:123], a[248:251], v[76:79], a[120:123]
    buffer_load_dwordx4 v1, s[32:35], s48 offen offset:1024 nt lds
    v_exp_f32 v47, v47
    v_exp_f32 v48, v48
    v_mfma_f32_16x16x32_bf16 a[124:127], a[252:255], v[76:79], a[124:127]
    v_exp_f32 v49, v49
    s_add_u32 m0, m0, 800
    v_mfma_f32_16x16x32_bf16 v[124:127], v[136:139], v[76:79], v[124:127]
    v_exp_f32 v50, v50
    v_exp_f32 v51, v51
    v_mfma_f32_16x16x32_bf16 a[128:131], a[224:227], v[80:83], a[128:131]
    buffer_load_dwordx4 v1, s[32:35], s48 offen offset:1280 nt lds
    v_exp_f32 v52, v52
    v_exp_f32 v53, v53
    v_mfma_f32_16x16x32_bf16 a[132:135], a[228:231], v[80:83], a[132:135]
    v_exp_f32 v54, v54
    s_add_u32 m0, m0, 800
    v_mfma_f32_16x16x32_bf16 a[136:139], a[232:235], v[80:83], a[136:139]
    v_exp_f32 v55, v55
    v_exp_f32 v56, v56
    v_mfma_f32_16x16x32_bf16 a[140:143], a[236:239], v[80:83], a[140:143]
    buffer_load_dwordx4 v1, s[32:35], s48 offen offset:1536 nt lds
    v_exp_f32 v57, v57
    v_exp_f32 v58, v58
    v_mfma_f32_16x16x32_bf16 a[144:147], a[240:243], v[80:83], a[144:147]
    v_exp_f32 v59, v59
    s_add_u32 m0, m0, 800
    v_mfma_f32_16x16x32_bf16 a[148:151], a[244:247], v[80:83], a[148:151]
    v_exp_f32 v60, v60
    v_exp_f32 v61, v61
    v_mfma_f32_16x16x32_bf16 a[152:155], a[248:251], v[80:83], a[152:155]
    buffer_load_dwordx4 v1, s[32:35], s48 offen offset:1792 nt lds
    v_exp_f32 v62, v62
    v_exp_f32 v63, v63
    v_mfma_f32_16x16x32_bf16 a[156:159], a[252:255], v[80:83], a[156:159]
    s_add_u32 s48, s48, s1
    v_cvt_pk_bf16_f32 v64, v16, v17
    v_mfma_f32_16x16x32_bf16 v[128:131], v[136:139], v[80:83], v[128:131]
    v_cvt_pk_bf16_f32 v65, v18, v19
    v_cvt_pk_bf16_f32 v66, v20, v21
    v_mfma_f32_16x16x32_bf16 a[160:163], a[224:227], v[84:87], a[160:163]
    v_cvt_pk_bf16_f32 v67, v22, v23
    v_cvt_pk_bf16_f32 v68, v24, v25
    v_cvt_pk_bf16_f32 v69, v26, v27
    v_mfma_f32_16x16x32_bf16 a[164:167], a[228:231], v[84:87], a[164:167]
    v_cvt_pk_bf16_f32 v70, v28, v29
    v_cvt_pk_bf16_f32 v71, v30, v31
    v_mfma_f32_16x16x32_bf16 a[168:171], a[232:235], v[84:87], a[168:171]
    v_cvt_pk_bf16_f32 v72, v32, v33
    v_cvt_pk_bf16_f32 v73, v34, v35
    v_mfma_f32_16x16x32_bf16 a[172:175], a[236:239], v[84:87], a[172:175]
    v_cvt_pk_bf16_f32 v74, v36, v37
    v_cvt_pk_bf16_f32 v75, v38, v39
    v_cvt_pk_bf16_f32 v76, v40, v41
    v_mfma_f32_16x16x32_bf16 a[176:179], a[240:243], v[84:87], a[176:179]
    v_cvt_pk_bf16_f32 v77, v42, v43
    v_cvt_pk_bf16_f32 v78, v44, v45
    v_mfma_f32_16x16x32_bf16 a[180:183], a[244:247], v[84:87], a[180:183]
    v_cvt_pk_bf16_f32 v79, v46, v47
    v_cvt_pk_bf16_f32 v80, v48, v49
    v_mfma_f32_16x16x32_bf16 a[184:187], a[248:251], v[84:87], a[184:187]
    v_cvt_pk_bf16_f32 v81, v50, v51
    v_cvt_pk_bf16_f32 v82, v52, v53
    v_cvt_pk_bf16_f32 v83, v54, v55
    v_mfma_f32_16x16x32_bf16 a[188:191], a[252:255], v[84:87], a[188:191]
    v_mfma_f32_16x16x32_bf16 v[132:135], v[136:139], v[84:87], v[132:135]
    v_cvt_pk_bf16_f32 v84, v56, v57
    v_cvt_pk_bf16_f32 v85, v58, v59
    v_cvt_pk_bf16_f32 v86, v60, v61
    v_cvt_pk_bf16_f32 v87, v62, v63
    s_cmp_eq_u32 s59, 0
    s_cbranch_scc1 L_sk5
    s_call_b64 s[62:63], L_rare2_6
L_sk5:
    v_mfma_f32_16x16x32_bf16 v[16:19], a[192:195], v[140:143], v[88:91]
    s_waitcnt vmcnt(8)
    v_mfma_f32_16x16x32_bf16 v[16:19], a[196:199], v[144:147], v[16:19]
    ds_read_b64_tr_b16 a[224:225], v8
    v_mfma_f32_16x16x32_bf16 v[16:19], a[200:203], v[148:151], v[16:19]
    ds_read_b64_tr_b16 a[226:227], v8 offset:512
    v_mfma_f32_16x16x32_bf16 v[16:19], a[204:207], v[152:155], v[16:19]
    v_mfma_f32_16x16x32_bf16 v[20:23], a[208:211], v[140:143], v[88:91]
    ds_read_b64_tr_b16 a[228:229], v8 offset:32
    v_mfma_f32_16x16x32_bf16 v[20:23], a[212:215], v[144:147], v[20:23]
    ds_read_b64_tr_b16 a[230:231], v8 offset:544
    v_mfma_f32_16x16x32_bf16 v[20:23], a[216:219], v[148:151], v[20:23]
    ds_read_b64_tr_b16 a[232:233], v8 offset:64
    v_mfma_f32_16x16x32_bf16 v[20:23], a[220:223], v[152:155], v[20:23]
    v_mfma_f32_16x16x32_bf16 v[24:27], a[192:195], v[156:159], v[92:95]
    ds_read_b64_tr_b16 a[234:235], v8 offset:576
    v_mfma_f32_16x16x32_bf16 v[24:27], a[196:199], v[160:163], v[24:27]
    ds_read_b64_tr_b16 a[236:237], v8 offset:96
    v_mfma_f32_16x16x32_bf16 v[24:27], a[200:203], v[164:167], v[24:27]
    ds_read_b64_tr_b16 a[238:239], v8 offset:608
    v_mfma_f32_16x16x32_bf16 v[24:27], a[204:207], v[168:171], v[24:27]
    v_mfma_f32_16x16x32_bf16 v[28:31], a[208:211], v[156:159], v[92:95]
    ds_read_b64_tr_b16 a[240:241], v8 offset:128
    v_mfma_f32_16x16x32_bf16 v[28:31], a[212:215], v[160:163], v[28:31]
    ds_read_b64_tr_b16 a[242:243], v8 offset:640
    v_mfma_f32_16x16x32_bf16 v[28:31], a[216:219], v[164:167], v[28:31]
    ds_read_b64_tr_b16 a[244:245], v8 offset:160
    v_mfma_f32_16x16x32_bf16 v[28:31], a[220:223], v[168:171], v[28:31]
    v_mfma_f32_16x16x32_bf16 v[32:35], a[192:195], v[172:175], v[96:99]
    ds_read_b64_tr_b16 a[246:247], v8 offset:672
    v_mfma_f32_16x16x32_bf16 v[32:35], a[196:199], v[176:179], v[32:35]
    ds_read_b64_tr_b16 a[248:249], v8 offset:192
    v_mfma_f32_16x16x32_bf16 v[32:35], a[200:203], v[180:183], v[32:35]
    ds_read_b64_tr_b16 a[250:251], v8 offset:704
    v_mfma_f32_16x16x32_bf16 v[32:35], a[204:207], v[184:187], v[32:35]
    v_mfma_f32_16x16x32_bf16 v[36:39], a[208:211], v[172:175], v[96:99]
    ds_read_b64_tr_b16 a[252:253], v8 offset:224
    v_mfma_f32_16x16x32_bf16 v[36:39], a[212:215], v[176:179], v[36:39]
    ds_read_b64_tr_b16 a[254:255], v8 offset:736
    v_mfma_f32_16x16x32_bf16 v[36:39], a[216:219], v[180:183], v[36:39]
    s_waitcnt lgkmcnt(0)
    v_mfma_f32_16x16x32_bf16 v[36:39], a[220:223], v[184:187], v[36:39]
    v_mfma_f32_16x16x32_bf16 v[40:43], a[192:195], v[188:191], v[100:103]
    s_add_u32 m0, s30, 0
    v_mfma_f32_16x16x32_bf16 v[40:43], a[196:199], v[192:195], v[40:43]
    buffer_load_dwordx4 v1, s[36:39], s52 offen nt lds
    v_mfma_f32_16x16x32_bf16 v[40:43], a[200:203], v[196:199], v[40:43]
    s_add_u32 m0, m0, 800
    v_mfma_f32_16x16x32_bf16 v[40:43], a[204:207], v[200:203], v[40:43]
    v_mfma_f32_16x16x32_bf16 v[44:47], a[208:211], v[188:191], v[100:103]
    buffer_load_dwordx4 v1, s[36:39], s52 offen offset:256 nt lds
    v_mfma_f32_16x16x32_bf16 v[44:47], a[212:215], v[192:195], v[44:47]
    s_add_u32 m0, m0, 800
    v_mfma_f32_16x16x32_bf16 v[44:47], a[216:219], v[196:199], v[44:47]
    buffer_load_dwordx4 v1, s[36:39], s52 offen offset:512 nt lds
    v_mfma_f32_16x16x32_bf16 v[44:47], a[220:223], v[200:203], v[44:47]
    v_mfma_f32_16x16x32_bf16 v[48:51], a[192:195], v[204:207], v[104:107]
    s_add_u32 m0, m0, 800
    v_mfma_f32_16x16x32_bf16 v[48:51], a[196:199], v[208:211], v[48:51]
    buffer_load_dwordx4 v1, s[36:39], s52 offen offset:768 nt lds
    v_mfma_f32_16x16x32_bf16 v[48:51], a[200:203], v[212:215], v[48:51]
    s_add_u32 m0, m0, 800
    v_mfma_f32_16x16x32_bf16 v[48:51], a[204:207], v[216:219], v[48:51]
    v_mfma_f32_16x16x32_bf16 v[52:55], a[208:211], v[204:207], v[104:107]
    buffer_load_dwordx4 v1, s[36:39], s52 offen offset:1024 nt lds
    v_mfma_f32_16x16x32_bf16 v[52:55], a[212:215], v[208:211], v[52:55]
    s_add_u32 m0, m0, 800
    v_mfma_f32_16x16x32_bf16 v[52:55], a[216:219], v[212:215], v[52:55]
    buffer_load_dwordx4 v1, s[36:39], s52 offen offset:1280 nt lds
    v_mfma_f32_16x16x32_bf16 v[52:55], a[220:223], v[216:219], v[52:55]
    v_mfma_f32_16x16x32_bf16 v[56:59], a[192:195], v[220:223], v[108:111]
    s_add_u32 m0, m0, 800
    v_mfma_f32_16x16x32_bf16 v[56:59], a[196:199], v[224:227], v[56:59]
    buffer_load_dwordx4 v1, s[36:39], s52 offen offset:1536 nt lds
    v_mfma_f32_16x16x32_bf16 v[56:59], a[200:203], v[228:231], v[56:59]
    s_add_u32 m0, m0, 800
    v_mfma_f32_16x16x32_bf16 v[56:59], a[204:207], v[232:235], v[56:59]
    v_mfma_f32_16x16x32_bf16 v[60:63], a[208:211], v[220:223], v[108:111]
    buffer_load_dwordx4 v1, s[36:39], s52 offen offset:1792 nt lds
    v_mfma_f32_16x16x32_bf16 v[60:63], a[212:215], v[224:227], v[60:63]
    s_add_u32 s52, s52, s1
    v_mfma_f32_16x16x32_bf16 v[60:63], a[216:219], v[228:231], v[60:63]
    s_add_u32 s57, s57, 1
    v_mfma_f32_16x16x32_bf16 v[60:63], a[220:223], v[232:235], v[60:63]
    s_cmp_lt_u32 s57, 6
    s_cbranch_scc1 L_loop_A
    s_cmp_eq_u32 s57, 7
    s_cbranch_scc1 L_exit_A
    s_mov_b32 s32, s70
    s_mov_b32 s33, s71
    s_mov_b32 s34, s77
    s_mul_i32 s48, s1, 7
    s_mov_b32 s36, s72
    s_mov_b32 s37, s73
    s_mov_b32 s38, s76
    s_mul_i32 s52, s1, 0
    s_branch L_loop_A
L_exit_A:
    s_mov_b32 s36, s72
    s_mov_b32 s37, s73
    s_mov_b32 s38, s76
    s_mul_i32 s52, s1, 1
    v_mfma_f32_16x16x32_bf16 a[0:3], a[224:227], v[64:67], a[0:3]
    v_max3_f32 v246, v16, v17, v18
    v_max3_f32 v246, v246, v19, v20
    v_mfma_f32_16x16x32_bf16 a[4:7], a[228:231], v[64:67], a[4:7]
    v_max3_f32 v246, v246, v21, v22
    v_max3_f32 v246, v246, v23, v24
    v_mfma_f32_16x16x32_bf16 a[8:11], a[232:235], v[64:67], a[8:11]
    v_max3_f32 v246, v246, v25, v26
    v_max3_f32 v246, v246, v27, v28
    v_mfma_f32_16x16x32_bf16 a[12:15], a[236:239], v[64:67], a[12:15]
    v_max3_f32 v246, v246, v29, v30
    v_max3_f32 v246, v246, v31, v32
    v_mfma_f32_16x16x32_bf16 a[16:19], a[240:243], v[64:67], a[16:19]
    v_max3_f32 v246, v246, v33, v34
    v_max3_f32 v246, v246, v35, v36
    v_mfma_f32_16x16x32_bf16 a[20:23], a[244:247], v[64:67], a[20:23]
    v_max3_f32 v246, v246, v37, v38
    v_mfma_f32_16x16x32_bf16 a[24:27], a[248:251], v[64:67], a[24:27]
    v_max_f32 v246, v246, v39
    v_max3_f32 v247, v40, v41, v42
    v_mfma_f32_16x16x32_bf16 a[28:31], a[252:255], v[64:67], a[28:31]
    v_max3_f32 v247, v247, v43, v44
    v_max3_f32 v247, v247, v45, v46
    v_mfma_f32_16x16x32_bf16 v[112:115], v[136:139], v[64:67], v[112:115]
    v_max3_f32 v247, v247, v47, v48
    v_max3_f32 v247, v247, v49, v50
    v_mfma_f32_16x16x32_bf16 a[32:35], a[224:227], v[68:71], a[32:35]
    v_max3_f32 v247, v247, v51, v52
    v_max3_f32 v247, v247, v53, v54
    v_mfma_f32_16x16x32_bf16 a[36:39], a[228:231], v[68:71], a[36:39]
    v_max3_f32 v247, v247, v55, v56
    v_max3_f32 v247, v247, v57, v58
    v_mfma_f32_16x16x32_bf16 a[40:43], a[232:235], v[68:71], a[40:43]
    v_max3_f32 v247, v247, v59, v60
    v_mfma_f32_16x16x32_bf16 a[44:47], a[236:239], v[68:71], a[44:47]
    v_max3_f32 v247, v247, v61, v62
    v_max_f32 v247, v247, v63
    v_mfma_f32_16x16x32_bf16 a[48:51], a[240:243], v[68:71], a[48:51]
    v_max_f32 v246, v246, v247
    v_cmp_lt_f32 vcc, s64, v246
    v_mfma_f32_16x16x32_bf16 a[52:55], a[244:247], v[68:71], a[52:55]
    s_cbranch_vccz L_sk6
    s_call_b64 s[62:63], L_rare1_6
L_sk6:
    v_exp_f32 v16, v16
    v_mfma_f32_16x16x32_bf16 a[56:59], a[248:251], v[68:71], a[56:59]
    v_exp_f32 v17, v17
    v_exp_f32 v18, v18
    v_mfma_f32_16x16x32_bf16 a[60:63], a[252:255], v[68:71], a[60:63]
    v_exp_f32 v19, v19
    v_exp_f32 v20, v20
    v_mfma_f32_16x16x32_bf16 v[116:119], v[136:139], v[68:71], v[116:119]
    v_exp_f32 v21, v21
    v_mfma_f32_16x16x32_bf16 a[64:67], a[224:227], v[72:75], a[64:67]
    v_exp_f32 v22, v22
    v_exp_f32 v23, v23
    v_mfma_f32_16x16x32_bf16 a[68:71], a[228:231], v[72:75], a[68:71]
    v_exp_f32 v24, v24
    v_exp_f32 v25, v25
    v_mfma_f32_16x16x32_bf16 a[72:75], a[232:235], v[72:75], a[72:75]
    v_exp_f32 v26, v26
    v_exp_f32 v27, v27
    v_mfma_f32_16x16x32_bf16 a[76:79], a[236:239], v[72:75], a[76:79]
    v_exp_f32 v28, v28
    v_exp_f32 v29, v29
    v_mfma_f32_16x16x32_bf16 a[80:83], a[240:243], v[72:75], a[80:83]
    v_exp_f32 v30, v30
    v_exp_f32 v31, v31
    v_mfma_f32_16x16x32_bf16 a[84:87], a[244:247], v[72:75], a[84:87]
    v_exp_f32 v32, v32
    v_mfma_f32_16x16x32_bf16 a[88:91], a[248:251], v[72:75], a[88:91]
    v_exp_f32 v33, v33
    v_exp_f32 v34, v34
    v_mfma_f32_16x16x32_bf16 a[92:95], a[252:255], v[72:75], a[92:95]
    v_exp_f32 v35, v35
    v_exp_f32 v36, v36
    v_mfma_f32_16x16x32_bf16 v[120:123], v[136:139], v[72:75], v[120:123]
    v_exp_f32 v37, v37
    v_exp_f32 v38, v38
    v_mfma_f32_16x16x32_bf16 a[96:99], a[224:227], v[76:79], a[96:99]
    v_exp_f32 v39, v39
    v_exp_f32 v40, v40
    v_mfma_f32_16x16x32_bf16 a[100:103], a[228:231], v[76:79], a[100:103]
    v_exp_f32 v41, v41
    v_exp_f32 v42, v42
    v_mfma_f32_16x16x32_bf16 a[104:107], a[232:235], v[76:79], a[104:107]
    v_exp_f32 v43, v43
    v_mfma_f32_16x16x32_bf16 a[108:111], a[236:239], v[76:79], a[108:111]
    v_exp_f32 v44, v44
    v_exp_f32 v45, v45
    v_mfma_f32_16x16x32_bf16 a[112:115], a[240:243], v[76:79], a[112:115]
    v_exp_f32 v46, v46
    v_exp_f32 v47, v47
    v_mfma_f32_16x16x32_bf16 a[116:119], a[244:247], v[76:79], a[116:119]
    v_exp_f32 v48, v48
    v_exp_f32 v49, v49
    v_mfma_f32_16x16x32_bf16 a[120:123], a[248:251], v[76:79], a[120:123]
    v_exp_f32 v50, v50
    v_exp_f32 v51, v51
    v_mfma_f32_16x16x32_bf16 a[124:127], a[252:255], v[76:79], a[124:127]
    v_exp_f32 v52, v52
    v_exp_f32 v53, v53
    v_mfma_f32_16x16x32_bf16 v[124:127], v[136:139], v[76:79], v[124:127]
    v_exp_f32 v54, v54
    v_mfma_f32_16x16x32_bf16 a[128:131], a[224:227], v[80:83], a[128:131]
    v_exp_f32 v55, v55
    v_exp_f32 v56, v56
    v_mfma_f32_16x16x32_bf16 a[132:135], a[228:231], v[80:83], a[132:135]
    v_exp_f32 v57, v57
    v_exp_f32 v58, v58
    v_mfma_f32_16x16x32_bf16 a[136:139], a[232:235], v[80:83], a[136:139]
    v_exp_f32 v59, v59
    v_exp_f32 v60, v60
    v_mfma_f32_16x16x32_bf16 a[140:143], a[236:239], v[80:83], a[140:143]
    v_exp_f32 v61, v61
    v_exp_f32 v62, v62
    v_mfma_f32_16x16x32_bf16 a[144:147], a[240:243], v[80:83], a[144:147]
    v_exp_f32 v63, v63
    v_cvt_pk_bf16_f32 v64, v16, v17
    v_mfma_f32_16x16x32_bf16 a[148:151], a[244:247], v[80:83], a[148:151]
    v_cvt_pk_bf16_f32 v65, v18, v19
    v_mfma_f32_16x16x32_bf16 a[152:155], a[248:251], v[80:83], a[152:155]
    v_cvt_pk_bf16_f32 v66, v20, v21
    v_cvt_pk_bf16_f32 v67, v22, v23
    v_mfma_f32_16x16x32_bf16 a[156:159], a[252:255], v[80:83], a[156:159]
    v_cvt_pk_bf16_f32 v68, v24, v25
    v_cvt_pk_bf16_f32 v69, v26, v27
    v_mfma_f32_16x16x32_bf16 v[128:131], v[136:139], v[80:83], v[128:131]
    v_cvt_pk_bf16_f32 v70, v28, v29
    v_cvt_pk_bf16_f32 v71, v30, v31
    v_mfma_f32_16x16x32_bf16 a[160:163], a[224:227], v[84:87], a[160:163]
    v_cvt_pk_bf16_f32 v72, v32, v33
    v_cvt_pk_bf16_f32 v73, v34, v35
    v_mfma_f32_16x16x32_bf16 a[164:167], a[228:231], v[84:87], a[164:167]
    v_cvt_pk_bf16_f32 v74, v36, v37
    v_cvt_pk_bf16_f32 v75, v38, v39
    v_mfma_f32_16x16x32_bf16 a[168:171], a[232:235], v[84:87], a[168:171]
    v_cvt_pk_bf16_f32 v76, v40, v41
    v_mfma_f32_16x16x32_bf16 a[172:175], a[236:239], v[84:87], a[172:175]
    v_cvt_pk_bf16_f32 v77, v42, v43
    v_cvt_pk_bf16_f32 v78, v44, v45
    v_mfma_f32_16x16x32_bf16 a[176:179], a[240:243], v[84:87], a[176:179]
    v_cvt_pk_bf16_f32 v79, v46, v47
    v_cvt_pk_bf16_f32 v80, v48, v49
    v_mfma_f32_16x16x32_bf16 a[180:183], a[244:247], v[84:87], a[180:183]
    v_cvt_pk_bf16_f32 v81, v50, v51
    v_cvt_pk_bf16_f32 v82, v52, v53
    v_mfma_f32_16x16x32_bf16 a[184:187], a[248:251], v[84:87], a[184:187]
    v_cvt_pk_bf16_f32 v83, v54, v55
    v_mfma_f32_16x16x32_bf16 a[188:191], a[252:255], v[84:87], a[188:191]
    v_mfma_f32_16x16x32_bf16 v[132:135], v[136:139], v[84:87], v[132:135]
    v_cvt_pk_bf16_f32 v84, v56, v57
    v_cvt_pk_bf16_f32 v85, v58, v59
    v_cvt_pk_bf16_f32 v86, v60, v61
    v_cvt_pk_bf16_f32 v87, v62, v63
    s_cmp_eq_u32 s59, 0
    s_cbranch_scc1 L_sk7
    s_call_b64 s[62:63], L_rare2_6
L_sk7:
    s_waitcnt vmcnt(8)
    ds_read_b64_tr_b16 a[224:225], v8 offset:8448
    ds_read_b64_tr_b16 a[226:227], v8 offset:8960
    ds_read_b64_tr_b16 a[228:229], v8 offset:8480
    ds_read_b64_tr_b16 a[230:231], v8 offset:8992
    ds_read_b64_tr_b16 a[232:233], v8 offset:8512
    ds_read_b64_tr_b16 a[234:235], v8 offset:9024
    ds_read_b64_tr_b16 a[236:237], v8 offset:8544
    ds_read_b64_tr_b16 a[238:239], v8 offset:9056
    ds_read_b64_tr_b16 a[240:241], v8 offset:8576
    ds_read_b64_tr_b16 a[242:243], v8 offset:9088
    ds_read_b64_tr_b16 a[244:245], v8 offset:8608
    ds_read_b64_tr_b16 a[246:247], v8 offset:9120
    ds_read_b64_tr_b16 a[248:249], v8 offset:8640
    ds_read_b64_tr_b16 a[250:251], v8 offset:9152
    ds_read_b64_tr_b16 a[252:253], v8 offset:8672
    ds_read_b64_tr_b16 a[254:255], v8 offset:9184
    s_waitcnt lgkmcnt(0)
    v_mfma_f32_16x16x32_bf16 a[0:3], a[224:227], v[64:67], a[0:3]
    s_add_u32 m0, s30, 8448
    v_mfma_f32_16x16x32_bf16 a[4:7], a[228:231], v[64:67], a[4:7]
    v_mfma_f32_16x16x32_bf16 a[8:11], a[232:235], v[64:67], a[8:11]
    v_mfma_f32_16x16x32_bf16 a[12:15], a[236:239], v[64:67], a[12:15]
    buffer_load_dwordx4 v1, s[36:39], s52 offen nt lds
    v_mfma_f32_16x16x32_bf16 a[16:19], a[240:243], v[64:67], a[16:19]
    v_mfma_f32_16x16x32_bf16 a[20:23], a[244:247], v[64:67], a[20:23]
    v_mfma_f32_16x16x32_bf16 a[24:27], a[248:251], v[64:67], a[24:27]
    s_add_u32 m0, m0, 800
    v_mfma_f32_16x16x32_bf16 a[28:31], a[252:255], v[64:67], a[28:31]
    v_mfma_f32_16x16x32_bf16 v[112:115], v[136:139], v[64:67], v[112:115]
    v_mfma_f32_16x16x32_bf16 a[32:35], a[224:227], v[68:71], a[32:35]
    buffer_load_dwordx4 v1, s[36:39], s52 offen offset:256 nt lds
    v_mfma_f32_16x16x32_bf16 a[36:39], a[228:231], v[68:71], a[36:39]
    v_mfma_f32_16x16x32_bf16 a[40:43], a[232:235], v[68:71], a[40:43]
    v_mfma_f32_16x16x32_bf16 a[44:47], a[236:239], v[68:71], a[44:47]
    s_add_u32 m0, m0, 800
    v_mfma_f32_16x16x32_bf16 a[48:51], a[240:243], v[68:71], a[48:51]
    v_mfma_f32_16x16x32_bf16 a[52:55], a[244:247], v[68:71], a[52:55]
    v_mfma_f32_16x16x32_bf16 a[56:59], a[248:251], v[68:71], a[56:59]
    buffer_load_dwordx4 v1, s[36:39], s52 offen offset:512 nt lds
    v_mfma_f32_16x16x32_bf16 a[60:63], a[252:255], v[68:71], a[60:63]
    v_mfma_f32_16x16x32_bf16 v[116:119], v[136:139], v[68:71], v[116:119]
    v_mfma_f32_16x16x32_bf16 a[64:67], a[224:227], v[72:75], a[64:67]
    v_mfma_f32_16x16x32_bf16 a[68:71], a[228:231], v[72:75], a[68:71]
    s_add_u32 m0, m0, 800
    v_mfma_f32_16x16x32_bf16 a[72:75], a[232:235], v[72:75], a[72:75]
    v_mfma_f32_16x16x32_bf16 a[76:79], a[236:239], v[72:75], a[76:79]
    v_mfma_f32_16x16x32_bf16 a[80:83], a[240:243], v[72:75], a[80:83]
    buffer_load_dwordx4 v1, s[36:39], s52 offen offset:768 nt lds
    v_mfma_f32_16x16x32_bf16 a[84:87], a[244:247], v[72:75], a[84:87]
    v_mfma_f32_16x16x32_bf16 a[88:91], a[248:251], v[72:75], a[88:91]
    v_mfma_f32_16x16x32_bf16 a[92:95], a[252:255], v[72:75], a[92:95]
    s_add_u32 m0, m0, 800
    v_mfma_f32_16x16x32_bf16 v[120:123], v[136:139], v[72:75], v[120:123]
    v_mfma_f32_16x16x32_bf16 a[96:99], a[224:227], v[76:79], a[96:99]
    v_mfma_f32_16x16x32_bf16 a[100:103], a[228:231], v[76:79], a[100:103]
    buffer_load_dwordx4 v1, s[36:39], s52 offen offset:1024 nt lds
    v_mfma_f32_16x16x32_bf16 a[104:107], a[232:235], v[76:79], a[104:107]
    v_mfma_f32_16x16x32_bf16 a[108:111], a[236:239], v[76:79], a[108:111]
    v_mfma_f32_16x16x32_bf16 a[112:115], a[240:243], v[76:79], a[112:115]
    s_add_u32 m0, m0, 800
    v_mfma_f32_16x16x32_bf16 a[116:119], a[244:247], v[76:79], a[116:119]
    v_mfma_f32_16x16x32_bf16 a[120:123], a[248:251], v[76:79], a[120:123]
    v_mfma_f32_16x16x32_bf16 a[124:127], a[252:255], v[76:79], a[124:127]
    buffer_load_dwordx4 v1, s[36:39], s52 offen offset:1280 nt lds
    v_mfma_f32_16x16x32_bf16 v[124:127], v[136:139], v[76:79], v[124:127]
    v_mfma_f32_16x16x32_bf16 a[128:131], a[224:227], v[80:83], a[128:131]
    v_mfma_f32_16x16x32_bf16 a[132:135], a[228:231], v[80:83], a[132:135]
    v_mfma_f32_16x16x32_bf16 a[136:139], a[232:235], v[80:83], a[136:139]
    s_add_u32 m0, m0, 800
    v_mfma_f32_16x16x32_bf16 a[140:143], a[236:239], v[80:83], a[140:143]
    v_mfma_f32_16x16x32_bf16 a[144:147], a[240:243], v[80:83], a[144:147]
    v_mfma_f32_16x16x32_bf16 a[148:151], a[244:247], v[80:83], a[148:151]
    buffer_load_dwordx4 v1, s[36:39], s52 offen offset:1536 nt lds
    v_mfma_f32_16x16x32_bf16 a[152:155], a[248:251], v[80:83], a[152:155]
    v_mfma_f32_16x16x32_bf16 a[156:159], a[252:255], v[80:83], a[156:159]
    v_mfma_f32_16x16x32_bf16 v[128:131], v[136:139], v[80:83], v[128:131]
    s_add_u32 m0, m0, 800
    v_mfma_f32_16x16x32_bf16 a[160:163], a[224:227], v[84:87], a[160:163]
    v_mfma_f32_16x16x32_bf16 a[164:167], a[228:231], v[84:87], a[164:167]
    v_mfma_f32_16x16x32_bf16 a[168:171], a[232:235], v[84:87], a[168:171]
    buffer_load_dwordx4 v1, s[36:39], s52 offen offset:1792 nt lds
    v_mfma_f32_16x16x32_bf16 a[172:175], a[236:239], v[84:87], a[172:175]
    v_mfma_f32_16x16x32_bf16 a[176:179], a[240:243], v[84:87], a[176:179]
    v_mfma_f32_16x16x32_bf16 a[180:183], a[244:247], v[84:87], a[180:183]
    s_add_u32 s52, s52, s1
    v_mfma_f32_16x16x32_bf16 a[184:187], a[248:251], v[84:87], a[184:187]
    v_mfma_f32_16x16x32_bf16 a[188:191], a[252:255], v[84:87], a[188:191]
    v_mfma_f32_16x16x32_bf16 v[132:135], v[136:139], v[84:87], v[132:135]
    s_lshl_b32 s79, s83, 17
    s_lshl_b32 s78, s3, 8
    s_add_u32 s79, s79, s78
    s_add_u32 s40, s12, s79
    s_addc_u32 s41, s13, 0
    s_mov_b32 s42, 261376
    s_mov_b32 s57, 131072
    s_call_b64 s[60:61], L_oppre
    s_call_b64 s[60:61], L_ofin0
    ds_read_b128 v[140:143], v14
    ds_read_b128 v[144:147], v14 offset:1024
    ds_read_b128 v[148:151], v14 offset:2048
    ds_read_b128 v[152:155], v14 offset:3072
    ds_read_b128 v[156:159], v14 offset:4096
    ds_read_b128 v[160:163], v14 offset:5120
    ds_read_b128 v[164:167], v14 offset:6144
    ds_read_b128 v[168:171], v14 offset:7168
    ds_read_b128 v[172:175], v14 offset:8192
    ds_read_b128 v[176:179], v14 offset:9216
    ds_read_b128 v[180:183], v14 offset:10240
    ds_read_b128 v[184:187], v14 offset:11264
    s_call_b64 s[60:61], L_ofin96
    ds_read_b128 v[88:91], v14
    ds_read_b128 v[92:95], v14 offset:1024
    ds_read_b128 v[96:99], v14 offset:2048
    ds_read_b128 v[100:103], v14 offset:3072
    ds_read_b128 v[104:107], v14 offset:4096
    ds_read_b128 v[108:111], v14 offset:5120
    ds_read_b128 v[112:115], v14 offset:6144
    ds_read_b128 v[116:119], v14 offset:7168
    ds_read_b128 v[120:123], v14 offset:8192
    ds_read_b128 v[124:127], v14 offset:9216
    ds_read_b128 v[128:131], v14 offset:10240
    ds_read_b128 v[132:135], v14 offset:11264
    s_call_b64 s[60:61], L_opart
    s_setpc_b64 s[94:95]
L_jobB:
    s_and_b32 s84, s81, 1
    s_lshl_b32 s31, s84, 1
    s_lshr_b32 s53, s82, 1
    s_and_b32 s53, s53, 3
    s_lshl_b32 s83, s80, 1
    s_add_u32 s83, s83, s84
    s_mov_b32 s100, 4096
    s_lshl_b32 s79, s83, 8
    s_lshl_b32 s78, s3, 6
    s_add_u32 s79, s79, s78
    s_add_u32 s40, s20, s79
    s_addc_u32 s41, s21, 0
    s_add_u32 s42, s100, 4186176
    s_mov_b32 s44, s14
    s_mov_b32 s45, s15
    s_mov_b32 s46, 786432
    s_mul_i32 s54, s82, 49152
    s_lshl_b32 s31, s80, 1
    s_add_u32 s31, s31, s84
    s_add_u32 s78, s82, 16
    s_lshl_b32 s85, s78, 8
    s_lshl_b32 s79, s31, 2
    s_add_u32 s85, s85, s79
    s_add_u32 s85, s85, 41943040
    s_lshl_b32 s78, s78, 4
    s_add_u32 s78, s78, s31
    s_lshl_b32 s78, s78, 2
    s_add_u32 s78, s78, s3
    s_mul_i32 s67, s78, 12288
    s_and_b32 s55, s3, 1
    s_lshl_b32 s78, s55, 13
    s_lshl_b32 s55, s55, 1
    s_lshl_b32 s31, s55, 2
    v_and_b32 v14, 15, v0
    v_xor_b32 v14, s31, v14
    v_lshlrev_b32 v14, 4, v14
    v_lshrrev_b32 v15, 4, v0
    v_lshl_add_u32 v1, v15, 11, v14
    s_mov_b32 s1, 16384
    s_sub_u32 s77, 262144, s78
    s_mov_b32 s0, s77
    s_lshl_b32 s79, s82, 5
    s_add_u32 s79, s79, s83
    s_lshr_b32 s31, s3, 1
    s_lshl_b32 s31, s31, 4
    s_add_u32 s79, s79, s31
    s_lshl_b32 s79, s79, 18
    s_add_u32 s79, s79, s78
    s_add_u32 s68, s16, s79
    s_addc_u32 s69, s17, 0
    s_add_u32 s70, s18, s79
    s_addc_u32 s71, s19, 0
    s_mov_b32 s72, s68
    s_mov_b32 s73, s69
    s_mov_b32 s76, 0
    s_call_b64 s[60:61], L_qproj2
    s_call_b64 s[60:61], L_qfin0
    s_cmp_ge_u32 s3, 2
    s_cbranch_scc1 L_sk8
    s_call_b64 s[60:61], L_qrdB
L_sk8:
    s_cmp_lg_u32 s3, 0
    s_cbranch_scc1 L_sp9
    s_cmp_eq_u32 s56, 0
    s_cbranch_scc1 L_sp9
    s_call_b64 s[62:63], L_nonce
    v_mov_b32 v14, s56
    v_mov_b32 v15, s93
    s_mov_b64 exec, 1
    global_store_dword v14, v15, s[28:29] sc1
    s_mov_b64 exec, -1
L_sp9:
    s_mov_b32 s56, 0
    s_call_b64 s[60:61], L_qfin96
    s_cmp_lt_u32 s3, 2
    s_cbranch_scc1 L_sk10
    s_call_b64 s[60:61], L_qrdB
L_sk10:
    s_mov_b32 s32, s68
    s_mov_b32 s33, s69
    s_mov_b32 s34, s77
    s_mul_i32 s48, s1, 2
    s_mov_b32 s36, s70
    s_mov_b32 s37, s71
    s_mov_b32 s38, s77
    s_mul_i32 s52, s1, 0
    s_waitcnt vmcnt(8)
    ds_read_b128 a[192:195], v7
    ds_read_b128 a[196:199], v7 offset:64
    ds_read_b128 a[200:203], v7 offset:128
    ds_read_b128 a[204:207], v7 offset:192
    ds_read_b128 a[208:211], v7 offset:512
    ds_read_b128 a[212:215], v7 offset:576
    ds_read_b128 a[216:219], v7 offset:640
    ds_read_b128 a[220:223], v7 offset:704
    v_accvgpr_write_b32 a0, 0
    v_accvgpr_write_b32 a1, 0
    v_accvgpr_write_b32 a2, 0
    v_accvgpr_write_b32 a3, 0
    v_accvgpr_write_b32 a4, 0
    v_accvgpr_write_b32 a5, 0
    v_accvgpr_write_b32 a6, 0
    v_accvgpr_write_b32 a7, 0
    v_accvgpr_write_b32 a8, 0
    v_accvgpr_write_b32 a9, 0
    v_accvgpr_write_b32 a10, 0
    v_accvgpr_write_b32 a11, 0
    v_accvgpr_write_b32 a12, 0
    v_accvgpr_write_b32 a13, 0
    v_accvgpr_write_b32 a14, 0
    v_accvgpr_write_b32 a15, 0
    v_accvgpr_write_b32 a16, 0
    v_accvgpr_write_b32 a17, 0
    v_accvgpr_write_b32 a18, 0
    v_accvgpr_write_b32 a19, 0
    v_accvgpr_write_b32 a20, 0
    v_accvgpr_write_b32 a21, 0
    v_accvgpr_write_b32 a22, 0
    v_accvgpr_write_b32 a23, 0
    v_accvgpr_write_b32 a24, 0
    v_accvgpr_write_b32 a25, 0
    v_accvgpr_write_b32 a26, 0
    v_accvgpr_write_b32 a27, 0
    v_accvgpr_write_b32 a28, 0
    v_accvgpr_write_b32 a29, 0
    v_accvgpr_write_b32 a30, 0
    v_accvgpr_write_b32 a31, 0
    v_accvgpr_write_b32 a32, 0
    v_accvgpr_write_b32 a33, 0
    v_accvgpr_write_b32 a34, 0
    v_accvgpr_write_b32 a35, 0
    v_accvgpr_write_b32 a36, 0
    v_accvgpr_write_b32 a37, 0
    v_accvgpr_write_b32 a38, 0
    v_accvgpr_write_b32 a39, 0
    v_accvgpr_write_b32 a40, 0
    v_accvgpr_write_b32 a41, 0
    v_accvgpr_write_b32 a42, 0
    v_accvgpr_write_b32 a43, 0
    v_accvgpr_write_b32 a44, 0
    v_accvgpr_write_b32 a45, 0
    v_accvgpr_write_b32 a46, 0
    v_accvgpr_write_b32 a47, 0
    s_waitcnt lgkmcnt(0)
    v_mfma_f32_16x16x32_bf16 v[16:19], a[192:195], v[140:143], 0
    s_add_u32 m0, s30, 0
    s_nop 0
    buffer_load_dwordx4 v1, s[36:39], s52 offen nt lds
    s_add_u32 m0, m0, 800
    s_nop 0
    buffer_load_dwordx4 v1, s[36:39], s52 offen offset:256 nt lds
    v_mfma_f32_16x16x32_bf16 v[16:19], a[196:199], v[144:147], v[16:19]
    s_add_u32 m0, m0, 800
    s_nop 0
    buffer_load_dwordx4 v1, s[36:39], s52 offen offset:512 nt lds
    s_add_u32 m0, m0, 800
    s_nop 0
    buffer_load_dwordx4 v1, s[36:39], s52 offen offset:768 nt lds
    v_mfma_f32_16x16x32_bf16 v[16:19], a[200:203], v[148:151], v[16:19]
    s_add_u32 m0, m0, 800
    s_nop 0
    buffer_load_dwordx4 v1, s[36:39], s52 offen offset:1024 nt lds
    s_add_u32 m0, m0, 800
    s_nop 0
    buffer_load_dwordx4 v1, s[36:39], s52 offen offset:1280 nt lds
    v_mfma_f32_16x16x32_bf16 v[16:19], a[204:207], v[152:155], v[16:19]
    s_add_u32 m0, m0, 800
    s_nop 0
    buffer_load_dwordx4 v1, s[36:39], s52 offen offset:1536 nt lds
    s_add_u32 m0, m0, 800
    s_nop 0
    buffer_load_dwordx4 v1, s[36:39], s52 offen offset:1792 nt lds
    v_mfma_f32_16x16x32_bf16 v[20:23], a[208:211], v[140:143], 0
    s_add_u32 s52, s52, s1
    v_accvgpr_write_b32 a48, 0
    v_accvgpr_write_b32 a49, 0
    v_accvgpr_write_b32 a50, 0
    v_mfma_f32_16x16x32_bf16 v[20:23], a[212:215], v[144:147], v[20:23]
    v_accvgpr_write_b32 a51, 0
    v_accvgpr_write_b32 a52, 0
    v_accvgpr_write_b32 a53, 0
    v_accvgpr_write_b32 a54, 0
    v_mfma_f32_16x16x32_bf16 v[20:23], a[216:219], v[148:151], v[20:23]
    v_accvgpr_write_b32 a55, 0
    v_accvgpr_write_b32 a56, 0
    v_accvgpr_write_b32 a57, 0
    v_accvgpr_write_b32 a58, 0
    v_mfma_f32_16x16x32_bf16 v[20:23], a[220:223], v[152:155], v[20:23]
    v_accvgpr_write_b32 a59, 0
    v_accvgpr_write_b32 a60, 0
    v_accvgpr_write_b32 a61, 0
    v_accvgpr_write_b32 a62, 0
    v_mfma_f32_16x16x32_bf16 v[24:27], a[192:195], v[156:159], 0
    v_accvgpr_write_b32 a63, 0
    v_accvgpr_write_b32 a64, 0
    v_accvgpr_write_b32 a65, 0
    v_accvgpr_write_b32 a66, 0
    v_mfma_f32_16x16x32_bf16 v[24:27], a[196:199], v[160:163], v[24:27]
    v_accvgpr_write_b32 a67, 0
    v_accvgpr_write_b32 a68, 0
    v_accvgpr_write_b32 a69, 0
    v_accvgpr_write_b32 a70, 0
    v_mfma_f32_16x16x32_bf16 v[24:27], a[200:203], v[164:167], v[24:27]
    v_accvgpr_write_b32 a71, 0
    v_accvgpr_write_b32 a72, 0
    v_accvgpr_write_b32 a73, 0
    v_accvgpr_write_b32 a74, 0
    v_mfma_f32_16x16x32_bf16 v[24:27], a[204:207], v[168:171], v[24:27]
    v_accvgpr_write_b32 a75, 0
    v_accvgpr_write_b32 a76, 0
    v_accvgpr_write_b32 a77, 0
    v_mfma_f32_16x16x32_bf16 v[28:31], a[208:211], v[156:159], 0
    v_accvgpr_write_b32 a78, 0
    v_accvgpr_write_b32 a79, 0
    v_accvgpr_write_b32 a80, 0
    v_accvgpr_write_b32 a81, 0
    v_mfma_f32_16x16x32_bf16 v[28:31], a[212:215], v[160:163], v[28:31]
    v_accvgpr_write_b32 a82, 0
    v_accvgpr_write_b32 a83, 0
    v_accvgpr_write_b32 a84, 0
    v_accvgpr_write_b32 a85, 0
    v_mfma_f32_16x16x32_bf16 v[28:31], a[216:219], v[164:167], v[28:31]
    v_accvgpr_write_b32 a86, 0
    v_accvgpr_write_b32 a87, 0
    v_accvgpr_write_b32 a88, 0
    v_accvgpr_write_b32 a89, 0
    v_mfma_f32_16x16x32_bf16 v[28:31], a[220:223], v[168:171], v[28:31]
    v_accvgpr_write_b32 a90, 0
    v_accvgpr_write_b32 a91, 0
    v_accvgpr_write_b32 a92, 0
    v_accvgpr_write_b32 a93, 0
    v_mfma_f32_16x16x32_bf16 v[32:35], a[192:195], v[172:175], 0
    v_accvgpr_write_b32 a94, 0
    v_accvgpr_write_b32 a95, 0
    v_mov_b32 v112, 0
    v_mov_b32 v88, 0
    v_mfma_f32_16x16x32_bf16 v[32:35], a[196:199], v[176:179], v[32:35]
    v_mov_b32 v113, 0
    v_mov_b32 v89, 0
    v_mov_b32 v114, 0
    v_mov_b32 v90, 0
    v_mfma_f32_16x16x32_bf16 v[32:35], a[200:203], v[180:183], v[32:35]
    v_mov_b32 v115, 0
    v_mov_b32 v91, 0
    v_mov_b32 v116, 0
    v_mov_b32 v92, 0
    v_mfma_f32_16x16x32_bf16 v[32:35], a[204:207], v[184:187], v[32:35]
    v_mov_b32 v117, 0
    v_mov_b32 v93, 0
    v_mov_b32 v118, 0
    v_mov_b32 v94, 0
    v_mfma_f32_16x16x32_bf16 v[36:39], a[208:211], v[172:175], 0
    v_mov_b32 v119, 0
    v_mov_b32 v95, 0
    v_mov_b32 v120, 0
    v_mov_b32 v96, 0
    v_mfma_f32_16x16x32_bf16 v[36:39], a[212:215], v[176:179], v[36:39]
    v_mov_b32 v121, 0
    v_mov_b32 v97, 0
    v_mov_b32 v122, 0
    v_mov_b32 v98, 0
    v_mfma_f32_16x16x32_bf16 v[36:39], a[216:219], v[180:183], v[36:39]
    v_mov_b32 v123, 0
    v_mov_b32 v99, 0
    v_mov_b32 v136, 0x3f803f80
    v_mov_b32 v137, 0x3f803f80
    v_mfma_f32_16x16x32_bf16 v[36:39], a[220:223], v[184:187], v[36:39]
    v_mov_b32 v138, 0x3f803f80
    v_mov_b32 v139, 0x3f803f80
    s_mov_b32 s65, 0xff800000
    s_waitcnt vmcnt(8)
    ds_read_b128 a[192:195], v7 offset:8448
    ds_read_b128 a[196:199], v7 offset:8512
    ds_read_b128 a[200:203], v7 offset:8576
    ds_read_b128 a[204:207], v7 offset:8640
    ds_read_b128 a[208:211], v7 offset:8960
    ds_read_b128 a[212:215], v7 offset:9024
    ds_read_b128 a[216:219], v7 offset:9088
    ds_read_b128 a[220:223], v7 offset:9152
    s_call_b64 s[62:63], L_rare1_3
    s_mov_b32 s65, 0
    s_mov_b32 s59, 0
    v_exp_f32 v16, v16
    v_exp_f32 v17, v17
    v_exp_f32 v18, v18
    v_exp_f32 v19, v19
    v_exp_f32 v20, v20
    v_exp_f32 v21, v21
    s_waitcnt lgkmcnt(0)
    v_exp_f32 v22, v22
    s_add_u32 m0, s30, 8448
    v_exp_f32 v23, v23
    buffer_load_dwordx4 v1, s[32:35], s48 offen nt lds
    v_exp_f32 v24, v24
    s_add_u32 m0, m0, 800
    v_exp_f32 v25, v25
    buffer_load_dwordx4 v1, s[32:35], s48 offen offset:256 nt lds
    v_exp_f32 v26, v26
    s_add_u32 m0, m0, 800
    v_exp_f32 v27, v27
    buffer_load_dwordx4 v1, s[32:35], s48 offen offset:512 nt lds
    v_exp_f32 v28, v28
    s_add_u32 m0, m0, 800
    v_exp_f32 v29, v29
    buffer_load_dwordx4 v1, s[32:35], s48 offen offset:768 nt lds
    v_exp_f32 v30, v30
    v_exp_f32 v31, v31
    s_add_u32 m0, m0, 800
    v_exp_f32 v32, v32
    buffer_load_dwordx4 v1, s[32:35], s48 offen offset:1024 nt lds
    v_exp_f32 v33, v33
    s_add_u32 m0, m0, 800
    v_exp_f32 v34, v34
    buffer_load_dwordx4 v1, s[32:35], s48 offen offset:1280 nt lds
    v_exp_f32 v35, v35
    s_add_u32 m0, m0, 800
    v_exp_f32 v36, v36
    buffer_load_dwordx4 v1, s[32:35], s48 offen offset:1536 nt lds
    v_exp_f32 v37, v37
    s_add_u32 m0, m0, 800
    v_exp_f32 v38, v38
    buffer_load_dwordx4 v1, s[32:35], s48 offen offset:1792 nt lds
    v_exp_f32 v39, v39
    s_add_u32 s48, s48, s1
    v_cvt_pk_bf16_f32 v64, v16, v17
    v_cvt_pk_bf16_f32 v65, v18, v19
    v_cvt_pk_bf16_f32 v66, v20, v21
    v_cvt_pk_bf16_f32 v67, v22, v23
    v_cvt_pk_bf16_f32 v68, v24, v25
    v_cvt_pk_bf16_f32 v69, v26, v27
    v_cvt_pk_bf16_f32 v70, v28, v29
    v_cvt_pk_bf16_f32 v71, v30, v31
    v_cvt_pk_bf16_f32 v72, v32, v33
    v_cvt_pk_bf16_f32 v73, v34, v35
    v_cvt_pk_bf16_f32 v74, v36, v37
    v_cvt_pk_bf16_f32 v75, v38, v39
    v_mfma_f32_16x16x32_bf16 v[16:19], a[192:195], v[140:143], v[88:91]
    s_waitcnt vmcnt(8)
    ds_read_b64_tr_b16 a[224:225], v8
    v_mfma_f32_16x16x32_bf16 v[16:19], a[196:199], v[144:147], v[16:19]
    ds_read_b64_tr_b16 a[226:227], v8 offset:512
    v_mfma_f32_16x16x32_bf16 v[16:19], a[200:203], v[148:151], v[16:19]
    ds_read_b64_tr_b16 a[228:229], v8 offset:32
    ds_read_b64_tr_b16 a[230:231], v8 offset:544
    v_mfma_f32_16x16x32_bf16 v[16:19], a[204:207], v[152:155], v[16:19]
    ds_read_b64_tr_b16 a[232:233], v8 offset:64
    v_mfma_f32_16x16x32_bf16 v[20:23], a[208:211], v[140:143], v[88:91]
    ds_read_b64_tr_b16 a[234:235], v8 offset:576
    ds_read_b64_tr_b16 a[236:237], v8 offset:96
    v_mfma_f32_16x16x32_bf16 v[20:23], a[212:215], v[144:147], v[20:23]
    ds_read_b64_tr_b16 a[238:239], v8 offset:608
    v_mfma_f32_16x16x32_bf16 v[20:23], a[216:219], v[148:151], v[20:23]
    ds_read_b64_tr_b16 a[240:241], v8 offset:128
    ds_read_b64_tr_b16 a[242:243], v8 offset:640
    v_mfma_f32_16x16x32_bf16 v[20:23], a[220:223], v[152:155], v[20:23]
    ds_read_b64_tr_b16 a[244:245], v8 offset:160
    v_mfma_f32_16x16x32_bf16 v[24:27], a[192:195], v[156:159], v[92:95]
    ds_read_b64_tr_b16 a[246:247], v8 offset:672
    ds_read_b64_tr_b16 a[248:249], v8 offset:192
    v_mfma_f32_16x16x32_bf16 v[24:27], a[196:199], v[160:163], v[24:27]
    ds_read_b64_tr_b16 a[250:251], v8 offset:704
    v_mfma_f32_16x16x32_bf16 v[24:27], a[200:203], v[164:167], v[24:27]
    ds_read_b64_tr_b16 a[252:253], v8 offset:224
    ds_read_b64_tr_b16 a[254:255], v8 offset:736
    v_mfma_f32_16x16x32_bf16 v[24:27], a[204:207], v[168:171], v[24:27]
    s_waitcnt lgkmcnt(0)
    v_mfma_f32_16x16x32_bf16 v[28:31], a[208:211], v[156:159], v[92:95]
    s_add_u32 m0, s30, 0
    s_nop 0
    buffer_load_dwordx4 v1, s[36:39], s52 offen nt lds
    v_mfma_f32_16x16x32_bf16 v[28:31], a[212:215], v[160:163], v[28:31]
    s_add_u32 m0, m0, 800
    v_mfma_f32_16x16x32_bf16 v[28:31], a[216:219], v[164:167], v[28:31]
    buffer_load_dwordx4 v1, s[36:39], s52 offen offset:256 nt lds
    s_add_u32 m0, m0, 800
    v_mfma_f32_16x16x32_bf16 v[28:31], a[220:223], v[168:171], v[28:31]
    buffer_load_dwordx4 v1, s[36:39], s52 offen offset:512 nt lds
    v_mfma_f32_16x16x32_bf16 v[32:35], a[192:195], v[172:175], v[96:99]
    s_add_u32 m0, m0, 800
    s_nop 0
    buffer_load_dwordx4 v1, s[36:39], s52 offen offset:768 nt lds
    v_mfma_f32_16x16x32_bf16 v[32:35], a[196:199], v[176:179], v[32:35]
    s_add_u32 m0, m0, 800
    v_mfma_f32_16x16x32_bf16 v[32:35], a[200:203], v[180:183], v[32:35]
    buffer_load_dwordx4 v1, s[36:39], s52 offen offset:1024 nt lds
    s_add_u32 m0, m0, 800
    v_mfma_f32_16x16x32_bf16 v[32:35], a[204:207], v[184:187], v[32:35]
    buffer_load_dwordx4 v1, s[36:39], s52 offen offset:1280 nt lds
    v_mfma_f32_16x16x32_bf16 v[36:39], a[208:211], v[172:175], v[96:99]
    s_add_u32 m0, m0, 800
    s_nop 0
    buffer_load_dwordx4 v1, s[36:39], s52 offen offset:1536 nt lds
    v_mfma_f32_16x16x32_bf16 v[36:39], a[212:215], v[176:179], v[36:39]
    s_add_u32 m0, m0, 800
    v_mfma_f32_16x16x32_bf16 v[36:39], a[216:219], v[180:183], v[36:39]
    buffer_load_dwordx4 v1, s[36:39], s52 offen offset:1792 nt lds
    s_add_u32 s52, s52, s1
    v_mfma_f32_16x16x32_bf16 v[36:39], a[220:223], v[184:187], v[36:39]
    s_mov_b32 s57, 1
L_loop_B:
    v_mfma_f32_16x16x32_bf16 a[0:3], a[224:227], v[64:67], a[0:3]
    s_waitcnt vmcnt(8)
    ds_read_b128 a[192:195], v7 offset:8448
    ds_read_b128 a[196:199], v7 offset:8512
    v_mfma_f32_16x16x32_bf16 a[4:7], a[228:231], v[64:67], a[4:7]
    ds_read_b128 a[200:203], v7 offset:8576
    ds_read_b128 a[204:207], v7 offset:8640
    ds_read_b128 a[208:211], v7 offset:8960
    v_mfma_f32_16x16x32_bf16 a[8:11], a[232:235], v[64:67], a[8:11]
    ds_read_b128 a[212:215], v7 offset:9024
    ds_read_b128 a[216:219], v7 offset:9088
    ds_read_b128 a[220:223], v7 offset:9152
    v_mfma_f32_16x16x32_bf16 a[12:15], a[236:239], v[64:67], a[12:15]
    v_max3_f32 v246, v16, v17, v18
    v_max3_f32 v246, v246, v19, v20
    v_max3_f32 v246, v246, v21, v22
    v_mfma_f32_16x16x32_bf16 a[16:19], a[240:243], v[64:67], a[16:19]
    v_max3_f32 v246, v246, v23, v24
    v_max3_f32 v246, v246, v25, v26
    v_max_f32 v246, v246, v27
    v_mfma_f32_16x16x32_bf16 a[20:23], a[244:247], v[64:67], a[20:23]
    v_max3_f32 v247, v28, v29, v30
    v_max3_f32 v247, v247, v31, v32
    v_max3_f32 v247, v247, v33, v34
    v_mfma_f32_16x16x32_bf16 a[24:27], a[248:251], v[64:67], a[24:27]
    v_max3_f32 v247, v247, v35, v36
    v_max3_f32 v247, v247, v37, v38
    v_max_f32 v247, v247, v39
    v_mfma_f32_16x16x32_bf16 a[28:31], a[252:255], v[64:67], a[28:31]
    v_max_f32 v246, v246, v247
    v_cmp_lt_f32 vcc, s64, v246
    s_cbranch_vccz L_sk11
    s_call_b64 s[62:63], L_rare1_3
L_sk11:
    v_mfma_f32_16x16x32_bf16 v[112:115], v[136:139], v[64:67], v[112:115]
    v_exp_f32 v16, v16
    v_exp_f32 v17, v17
    v_mfma_f32_16x16x32_bf16 a[32:35], a[224:227], v[68:71], a[32:35]
    v_exp_f32 v18, v18
    v_exp_f32 v19, v19
    v_exp_f32 v20, v20
    v_mfma_f32_16x16x32_bf16 a[36:39], a[228:231], v[68:71], a[36:39]
    v_exp_f32 v21, v21
    s_waitcnt lgkmcnt(0)
    v_exp_f32 v22, v22
    v_mfma_f32_16x16x32_bf16 a[40:43], a[232:235], v[68:71], a[40:43]
    s_add_u32 m0, s30, 8448
    v_exp_f32 v23, v23
    buffer_load_dwordx4 v1, s[32:35], s48 offen nt lds
    v_mfma_f32_16x16x32_bf16 a[44:47], a[236:239], v[68:71], a[44:47]
    v_exp_f32 v24, v24
    s_add_u32 m0, m0, 800
    v_exp_f32 v25, v25
    v_mfma_f32_16x16x32_bf16 a[48:51], a[240:243], v[68:71], a[48:51]
    buffer_load_dwordx4 v1, s[32:35], s48 offen offset:256 nt lds
    v_exp_f32 v26, v26
    s_add_u32 m0, m0, 800
    v_mfma_f32_16x16x32_bf16 a[52:55], a[244:247], v[68:71], a[52:55]
    v_exp_f32 v27, v27
    buffer_load_dwordx4 v1, s[32:35], s48 offen offset:512 nt lds
    v_exp_f32 v28, v28
    v_mfma_f32_16x16x32_bf16 a[56:59], a[248:251], v[68:71], a[56:59]
    s_add_u32 m0, m0, 800
    v_exp_f32 v29, v29
    buffer_load_dwordx4 v1, s[32:35], s48 offen offset:768 nt lds
    v_mfma_f32_16x16x32_bf16 a[60:63], a[252:255], v[68:71], a[60:63]
    v_exp_f32 v30, v30
    v_exp_f32 v31, v31
    s_add_u32 m0, m0, 800
    v_mfma_f32_16x16x32_bf16 v[116:119], v[136:139], v[68:71], v[116:119]
    v_exp_f32 v32, v32
    buffer_load_dwordx4 v1, s[32:35], s48 offen offset:1024 nt lds
    v_mfma_f32_16x16x32_bf16 a[64:67], a[224:227], v[72:75], a[64:67]
    v_exp_f32 v33, v33
    s_add_u32 m0, m0, 800
    v_exp_f32 v34, v34
    v_mfma_f32_16x16x32_bf16 a[68:71], a[228:231], v[72:75], a[68:71]
    buffer_load_dwordx4 v1, s[32:35], s48 offen offset:1280 nt lds
    v_exp_f32 v35, v35
    s_add_u32 m0, m0, 800
    v_mfma_f32_16x16x32_bf16 a[72:75], a[232:235], v[72:75], a[72:75]
    v_exp_f32 v36, v36
    buffer_load_dwordx4 v1, s[32:35], s48 offen offset:1536 nt lds
    v_exp_f32 v37, v37
    v_mfma_f32_16x16x32_bf16 a[76:79], a[236:239], v[72:75], a[76:79]
    s_add_u32 m0, m0, 800
    v_exp_f32 v38, v38
    buffer_load_dwordx4 v1, s[32:35], s48 offen offset:1792 nt lds
    v_mfma_f32_16x16x32_bf16 a[80:83], a[240:243], v[72:75], a[80:83]
    v_exp_f32 v39, v39
    s_add_u32 s48, s48, s1
    v_cvt_pk_bf16_f32 v64, v16, v17
    v_mfma_f32_16x16x32_bf16 a[84:87], a[244:247], v[72:75], a[84:87]
    v_cvt_pk_bf16_f32 v65, v18, v19
    v_cvt_pk_bf16_f32 v66, v20, v21
    v_cvt_pk_bf16_f32 v67, v22, v23
    v_mfma_f32_16x16x32_bf16 a[88:91], a[248:251], v[72:75], a[88:91]
    v_cvt_pk_bf16_f32 v68, v24, v25
    v_cvt_pk_bf16_f32 v69, v26, v27
    v_cvt_pk_bf16_f32 v70, v28, v29
    v_mfma_f32_16x16x32_bf16 a[92:95], a[252:255], v[72:75], a[92:95]
    v_cvt_pk_bf16_f32 v71, v30, v31
    v_mfma_f32_16x16x32_bf16 v[120:123], v[136:139], v[72:75], v[120:123]
    v_cvt_pk_bf16_f32 v72, v32, v33
    v_cvt_pk_bf16_f32 v73, v34, v35
    v_cvt_pk_bf16_f32 v74, v36, v37
    v_cvt_pk_bf16_f32 v75, v38, v39
    s_cmp_eq_u32 s59, 0
    s_cbranch_scc1 L_sk12
    s_call_b64 s[62:63], L_rare2_3
L_sk12:
    v_mfma_f32_16x16x32_bf16 v[16:19], a[192:195], v[140:143], v[88:91]
    s_waitcnt vmcnt(8)
    ds_read_b64_tr_b16 a[224:225], v8
    v_mfma_f32_16x16x32_bf16 v[16:19], a[196:199], v[144:147], v[16:19]
    ds_read_b64_tr_b16 a[226:227], v8 offset:512
    v_mfma_f32_16x16x32_bf16 v[16:19], a[200:203], v[148:151], v[16:19]
    ds_read_b64_tr_b16 a[228:229], v8 offset:32
    ds_read_b64_tr_b16 a[230:231], v8 offset:544
    v_mfma_f32_16x16x32_bf16 v[16:19], a[204:207], v[152:155], v[16:19]
    ds_read_b64_tr_b16 a[232:233], v8 offset:64
    v_mfma_f32_16x16x32_bf16 v[20:23], a[208:211], v[140:143], v[88:91]
    ds_read_b64_tr_b16 a[234:235], v8 offset:576
    ds_read_b64_tr_b16 a[236:237], v8 offset:96
    v_mfma_f32_16x16x32_bf16 v[20:23], a[212:215], v[144:147], v[20:23]
    ds_read_b64_tr_b16 a[238:239], v8 offset:608
    v_mfma_f32_16x16x32_bf16 v[20:23], a[216:219], v[148:151], v[20:23]
    ds_read_b64_tr_b16 a[240:241], v8 offset:128
    ds_read_b64_tr_b16 a[242:243], v8 offset:640
    v_mfma_f32_16x16x32_bf16 v[20:23], a[220:223], v[152:155], v[20:23]
    ds_read_b64_tr_b16 a[244:245], v8 offset:160
    v_mfma_f32_16x16x32_bf16 v[24:27], a[192:195], v[156:159], v[92:95]
    ds_read_b64_tr_b16 a[246:247], v8 offset:672
    ds_read_b64_tr_b16 a[248:249], v8 offset:192
    v_mfma_f32_16x16x32_bf16 v[24:27], a[196:199], v[160:163], v[24:27]
    ds_read_b64_tr_b16 a[250:251], v8 offset:704
    v_mfma_f32_16x16x32_bf16 v[24:27], a[200:203], v[164:167], v[24:27]
    ds_read_b64_tr_b16 a[252:253], v8 offset:224
    ds_read_b64_tr_b16 a[254:255], v8 offset:736
    v_mfma_f32_16x16x32_bf16 v[24:27], a[204:207], v[168:171], v[24:27]
    s_waitcnt lgkmcnt(0)
    v_mfma_f32_16x16x32_bf16 v[28:31], a[208:211], v[156:159], v[92:95]
    s_add_u32 m0, s30, 0
    s_nop 0
    buffer_load_dwordx4 v1, s[36:39], s52 offen nt lds
    v_mfma_f32_16x16x32_bf16 v[28:31], a[212:215], v[160:163], v[28:31]
    s_add_u32 m0, m0, 800
    v_mfma_f32_16x16x32_bf16 v[28:31], a[216:219], v[164:167], v[28:31]
    buffer_load_dwordx4 v1, s[36:39], s52 offen offset:256 nt lds
    s_add_u32 m0, m0, 800
    v_mfma_f32_16x16x32_bf16 v[28:31], a[220:223], v[168:171], v[28:31]
    buffer_load_dwordx4 v1, s[36:39], s52 offen offset:512 nt lds
    v_mfma_f32_16x16x32_bf16 v[32:35], a[192:195], v[172:175], v[96:99]
    s_add_u32 m0, m0, 800
    s_nop 0
    buffer_load_dwordx4 v1, s[36:39], s52 offen offset:768 nt lds
    v_mfma_f32_16x16x32_bf16 v[32:35], a[196:199], v[176:179], v[32:35]
    s_add_u32 m0, m0, 800
    v_mfma_f32_16x16x32_bf16 v[32:35], a[200:203], v[180:183], v[32:35]
    buffer_load_dwordx4 v1, s[36:39], s52 offen offset:1024 nt lds
    s_add_u32 m0, m0, 800
    v_mfma_f32_16x16x32_bf16 v[32:35], a[204:207], v[184:187], v[32:35]
    buffer_load_dwordx4 v1, s[36:39], s52 offen offset:1280 nt lds
    v_mfma_f32_16x16x32_bf16 v[36:39], a[208:211], v[172:175], v[96:99]
    s_add_u32 m0, m0, 800
    s_nop 0
    buffer_load_dwordx4 v1, s[36:39], s52 offen offset:1536 nt lds
    v_mfma_f32_16x16x32_bf16 v[36:39], a[212:215], v[176:179], v[36:39]
    s_add_u32 m0, m0, 800
    v_mfma_f32_16x16x32_bf16 v[36:39], a[216:219], v[180:183], v[36:39]
    buffer_load_dwordx4 v1, s[36:39], s52 offen offset:1792 nt lds
    s_add_u32 s52, s52, s1
    v_mfma_f32_16x16x32_bf16 v[36:39], a[220:223], v[184:187], v[36:39]
    s_add_u32 s57, s57, 1
    s_cmp_lt_u32 s57, 14
    s_cbranch_scc1 L_loop_B
    s_cmp_eq_u32 s57, 15
    s_cbranch_scc1 L_exit_B
    s_mov_b32 s32, s70
    s_mov_b32 s33, s71
    s_mov_b32 s34, s77
    s_mul_i32 s48, s1, 15
    s_mov_b32 s36, s72
    s_mov_b32 s37, s73
    s_mov_b32 s38, s76
    s_mul_i32 s52, s1, 0
    s_branch L_loop_B
L_exit_B:
    s_mov_b32 s36, s72
    s_mov_b32 s37, s73
    s_mov_b32 s38, s76
    s_mul_i32 s52, s1, 1
    v_mfma_f32_16x16x32_bf16 a[0:3], a[224:227], v[64:67], a[0:3]
    v_max3_f32 v246, v16, v17, v18
    v_max3_f32 v246, v246, v19, v20
    v_mfma_f32_16x16x32_bf16 a[4:7], a[228:231], v[64:67], a[4:7]
    v_max3_f32 v246, v246, v21, v22
    v_max3_f32 v246, v246, v23, v24
    v_mfma_f32_16x16x32_bf16 a[8:11], a[232:235], v[64:67], a[8:11]
    v_max3_f32 v246, v246, v25, v26
    v_max_f32 v246, v246, v27
    v_mfma_f32_16x16x32_bf16 a[12:15], a[236:239], v[64:67], a[12:15]
    v_max3_f32 v247, v28, v29, v30
    v_max3_f32 v247, v247, v31, v32
    v_mfma_f32_16x16x32_bf16 a[16:19], a[240:243], v[64:67], a[16:19]
    v_max3_f32 v247, v247, v33, v34
    v_max3_f32 v247, v247, v35, v36
    v_mfma_f32_16x16x32_bf16 a[20:23], a[244:247], v[64:67], a[20:23]
    v_max3_f32 v247, v247, v37, v38
    v_max_f32 v247, v247, v39
    v_mfma_f32_16x16x32_bf16 a[24:27], a[248:251], v[64:67], a[24:27]
    v_max_f32 v246, v246, v247
    v_cmp_lt_f32 vcc, s64, v246
    v_mfma_f32_16x16x32_bf16 a[28:31], a[252:255], v[64:67], a[28:31]
    s_cbranch_vccz L_sk13
    s_call_b64 s[62:63], L_rare1_3
L_sk13:
    v_exp_f32 v16, v16
    v_mfma_f32_16x16x32_bf16 v[112:115], v[136:139], v[64:67], v[112:115]
    v_exp_f32 v17, v17
    v_mfma_f32_16x16x32_bf16 a[32:35], a[224:227], v[68:71], a[32:35]
    v_exp_f32 v18, v18
    v_exp_f32 v19, v19
    v_mfma_f32_16x16x32_bf16 a[36:39], a[228:231], v[68:71], a[36:39]
    v_exp_f32 v20, v20
    v_exp_f32 v21, v21
    v_mfma_f32_16x16x32_bf16 a[40:43], a[232:235], v[68:71], a[40:43]
    v_exp_f32 v22, v22
    v_exp_f32 v23, v23
    v_mfma_f32_16x16x32_bf16 a[44:47], a[236:239], v[68:71], a[44:47]
    v_exp_f32 v24, v24
    v_exp_f32 v25, v25
    v_mfma_f32_16x16x32_bf16 a[48:51], a[240:243], v[68:71], a[48:51]
    v_exp_f32 v26, v26
    v_exp_f32 v27, v27
    v_mfma_f32_16x16x32_bf16 a[52:55], a[244:247], v[68:71], a[52:55]
    v_exp_f32 v28, v28
    v_exp_f32 v29, v29
    v_mfma_f32_16x16x32_bf16 a[56:59], a[248:251], v[68:71], a[56:59]
    v_exp_f32 v30, v30
    v_exp_f32 v31, v31
    v_mfma_f32_16x16x32_bf16 a[60:63], a[252:255], v[68:71], a[60:63]
    v_exp_f32 v32, v32
    v_exp_f32 v33, v33
    v_mfma_f32_16x16x32_bf16 v[116:119], v[136:139], v[68:71], v[116:119]
    v_exp_f32 v34, v34
    v_mfma_f32_16x16x32_bf16 a[64:67], a[224:227], v[72:75], a[64:67]
    v_exp_f32 v35, v35
    v_exp_f32 v36, v36
    v_mfma_f32_16x16x32_bf16 a[68:71], a[228:231], v[72:75], a[68:71]
    v_exp_f32 v37, v37
    v_exp_f32 v38, v38
    v_mfma_f32_16x16x32_bf16 a[72:75], a[232:235], v[72:75], a[72:75]
    v_exp_f32 v39, v39
    v_cvt_pk_bf16_f32 v64, v16, v17
    v_mfma_f32_16x16x32_bf16 a[76:79], a[236:239], v[72:75], a[76:79]
    v_cvt_pk_bf16_f32 v65, v18, v19
    v_cvt_pk_bf16_f32 v66, v20, v21
    v_mfma_f32_16x16x32_bf16 a[80:83], a[240:243], v[72:75], a[80:83]
    v_cvt_pk_bf16_f32 v67, v22, v23
    v_cvt_pk_bf16_f32 v68, v24, v25
    v_mfma_f32_16x16x32_bf16 a[84:87], a[244:247], v[72:75], a[84:87]
    v_cvt_pk_bf16_f32 v69, v26, v27
    v_cvt_pk_bf16_f32 v70, v28, v29
    v_mfma_f32_16x16x32_bf16 a[88:91], a[248:251], v[72:75], a[88:91]
    v_cvt_pk_bf16_f32 v71, v30, v31
    v_mfma_f32_16x16x32_bf16 a[92:95], a[252:255], v[72:75], a[92:95]
    v_mfma_f32_16x16x32_bf16 v[120:123], v[136:139], v[72:75], v[120:123]
    v_cvt_pk_bf16_f32 v72, v32, v33
    v_cvt_pk_bf16_f32 v73, v34, v35
    v_cvt_pk_bf16_f32 v74, v36, v37
    v_cvt_pk_bf16_f32 v75, v38, v39
    s_cmp_eq_u32 s59, 0
    s_cbranch_scc1 L_sk14
    s_call_b64 s[62:63], L_rare2_3
L_sk14:
    s_waitcnt vmcnt(8)
    ds_read_b64_tr_b16 a[224:225], v8 offset:8448
    ds_read_b64_tr_b16 a[226:227], v8 offset:8960
    ds_read_b64_tr_b16 a[228:229], v8 offset:8480
    ds_read_b64_tr_b16 a[230:231], v8 offset:8992
    ds_read_b64_tr_b16 a[232:233], v8 offset:8512
    ds_read_b64_tr_b16 a[234:235], v8 offset:9024
    ds_read_b64_tr_b16 a[236:237], v8 offset:8544
    ds_read_b64_tr_b16 a[238:239], v8 offset:9056
    ds_read_b64_tr_b16 a[240:241], v8 offset:8576
    ds_read_b64_tr_b16 a[242:243], v8 offset:9088
    ds_read_b64_tr_b16 a[244:245], v8 offset:8608
    ds_read_b64_tr_b16 a[246:247], v8 offset:9120
    ds_read_b64_tr_b16 a[248:249], v8 offset:8640
    ds_read_b64_tr_b16 a[250:251], v8 offset:9152
    ds_read_b64_tr_b16 a[252:253], v8 offset:8672
    ds_read_b64_tr_b16 a[254:255], v8 offset:9184
    s_waitcnt lgkmcnt(0)
    v_mfma_f32_16x16x32_bf16 a[0:3], a[224:227], v[64:67], a[0:3]
    s_add_u32 m0, s30, 8448
    v_mfma_f32_16x16x32_bf16 a[4:7], a[228:231], v[64:67], a[4:7]
    buffer_load_dwordx4 v1, s[36:39], s52 offen nt lds
    v_mfma_f32_16x16x32_bf16 a[8:11], a[232:235], v[64:67], a[8:11]
    v_mfma_f32_16x16x32_bf16 a[12:15], a[236:239], v[64:67], a[12:15]
    s_add_u32 m0, m0, 800
    v_mfma_f32_16x16x32_bf16 a[16:19], a[240:243], v[64:67], a[16:19]
    buffer_load_dwordx4 v1, s[36:39], s52 offen offset:256 nt lds
    v_mfma_f32_16x16x32_bf16 a[20:23], a[244:247], v[64:67], a[20:23]
    v_mfma_f32_16x16x32_bf16 a[24:27], a[248:251], v[64:67], a[24:27]
    s_add_u32 m0, m0, 800
    v_mfma_f32_16x16x32_bf16 a[28:31], a[252:255], v[64:67], a[28:31]
    buffer_load_dwordx4 v1, s[36:39], s52 offen offset:512 nt lds
    v_mfma_f32_16x16x32_bf16 v[112:115], v[136:139], v[64:67], v[112:115]
    v_mfma_f32_16x16x32_bf16 a[32:35], a[224:227], v[68:71], a[32:35]
    s_add_u32 m0, m0, 800
    v_mfma_f32_16x16x32_bf16 a[36:39], a[228:231], v[68:71], a[36:39]
    v_mfma_f32_16x16x32_bf16 a[40:43], a[232:235], v[68:71], a[40:43]
    buffer_load_dwordx4 v1, s[36:39], s52 offen offset:768 nt lds
    v_mfma_f32_16x16x32_bf16 a[44:47], a[236:239], v[68:71], a[44:47]
    s_add_u32 m0, m0, 800
    v_mfma_f32_16x16x32_bf16 a[48:51], a[240:243], v[68:71], a[48:51]
    v_mfma_f32_16x16x32_bf16 a[52:55], a[244:247], v[68:71], a[52:55]
    buffer_load_dwordx4 v1, s[36:39], s52 offen offset:1024 nt lds
    v_mfma_f32_16x16x32_bf16 a[56:59], a[248:251], v[68:71], a[56:59]
    s_add_u32 m0, m0, 800
    v_mfma_f32_16x16x32_bf16 a[60:63], a[252:255], v[68:71], a[60:63]
    v_mfma_f32_16x16x32_bf16 v[116:119], v[136:139], v[68:71], v[116:119]
    buffer_load_dwordx4 v1, s[36:39], s52 offen offset:1280 nt lds
    v_mfma_f32_16x16x32_bf16 a[64:67], a[224:227], v[72:75], a[64:67]
    v_mfma_f32_16x16x32_bf16 a[68:71], a[228:231], v[72:75], a[68:71]
    s_add_u32 m0, m0, 800
    v_mfma_f32_16x16x32_bf16 a[72:75], a[232:235], v[72:75], a[72:75]
    buffer_load_dwordx4 v1, s[36:39], s52 offen offset:1536 nt lds
    v_mfma_f32_16x16x32_bf16 a[76:79], a[236:239], v[72:75], a[76:79]
    v_mfma_f32_16x16x32_bf16 a[80:83], a[240:243], v[72:75], a[80:83]
    s_add_u32 m0, m0, 800
    v_mfma_f32_16x16x32_bf16 a[84:87], a[244:247], v[72:75], a[84:87]
    buffer_load_dwordx4 v1, s[36:39], s52 offen offset:1792 nt lds
    v_mfma_f32_16x16x32_bf16 a[88:91], a[248:251], v[72:75], a[88:91]
    v_mfma_f32_16x16x32_bf16 a[92:95], a[252:255], v[72:75], a[92:95]
    s_add_u32 s52, s52, s1
    v_mfma_f32_16x16x32_bf16 v[120:123], v[136:139], v[72:75], v[120:123]
    s_lshl_b32 s79, s83, 17
    s_lshl_b32 s78, s3, 8
    s_add_u32 s79, s79, s78
    s_add_u32 s40, s22, s79
    s_addc_u32 s41, s23, 0
    s_mov_b32 s42, 2227456
    s_mov_b32 s57, 2097152
    s_call_b64 s[60:61], L_oppre
    s_call_b64 s[60:61], L_ofinB
    s_call_b64 s[60:61], L_opart
    s_setpc_b64 s[94:95]
L_qrdB:
    s_xor_b32 s31, s55, 0
    s_lshl_b32 s31, s31, 6
    v_add_u32 v248, s31, v12
    s_xor_b32 s31, s55, 1
    s_lshl_b32 s31, s31, 6
    v_add_u32 v249, s31, v12
    s_xor_b32 s31, s55, 2
    s_lshl_b32 s31, s31, 6
    v_add_u32 v250, s31, v12
    s_xor_b32 s31, s55, 3
    s_lshl_b32 s31, s31, 6
    v_add_u32 v251, s31, v12
    ds_read_b128 v[140:143], v248
    ds_read_b128 v[144:147], v249
    ds_read_b128 v[148:151], v250
    ds_read_b128 v[152:155], v251
    ds_read_b128 v[156:159], v248 offset:4608
    ds_read_b128 v[160:163], v249 offset:4608
    ds_read_b128 v[164:167], v250 offset:4608
    ds_read_b128 v[168:171], v251 offset:4608
    ds_read_b128 v[172:175], v248 offset:9216
    ds_read_b128 v[176:179], v249 offset:9216
    ds_read_b128 v[180:183], v250 offset:9216
    ds_read_b128 v[184:187], v251 offset:9216
    s_waitcnt lgkmcnt(0)
    s_setpc_b64 s[60:61]
L_qproj2:
    s_waitcnt lgkmcnt(0)
    s_barrier
    s_mul_i32 s79, s3, 12288
    s_add_u32 s79, s79, s54
    s_add_u32 m0, s30, 16896
    s_add_u32 s31, s79, 0
    buffer_load_dwordx4 v10, s[44:47], s31 offen lds
    s_add_u32 m0, s30, 17952
    s_add_u32 s31, s79, 1024
    buffer_load_dwordx4 v10, s[44:47], s31 offen lds
    s_add_u32 m0, s30, 19008
    s_add_u32 s31, s79, 2048
    buffer_load_dwordx4 v10, s[44:47], s31 offen lds
    s_add_u32 m0, s30, 20064
    s_add_u32 s31, s79, 3072
    buffer_load_dwordx4 v10, s[44:47], s31 offen lds
    s_add_u32 m0, s30, 21120
    s_add_u32 s31, s79, 4096
    buffer_load_dwordx4 v10, s[44:47], s31 offen lds
    s_add_u32 m0, s30, 22176
    s_add_u32 s31, s79, 5120
    buffer_load_dwordx4 v10, s[44:47], s31 offen lds
    s_add_u32 m0, s30, 23232
    s_add_u32 s31, s79, 6144
    buffer_load_dwordx4 v10, s[44:47], s31 offen lds
    s_add_u32 m0, s30, 24288
    s_add_u32 s31, s79, 7168
    buffer_load_dwordx4 v10, s[44:47], s31 offen lds
    s_add_u32 m0, s30, 25344
    s_add_u32 s31, s79, 8192
    buffer_load_dwordx4 v10, s[44:47], s31 offen lds
    s_add_u32 m0, s30, 26400
    s_add_u32 s31, s79, 9216
    buffer_load_dwordx4 v10, s[44:47], s31 offen lds
    s_add_u32 m0, s30, 27456
    s_add_u32 s31, s79, 10240
    buffer_load_dwordx4 v10, s[44:47], s31 offen lds
    s_add_u32 m0, s30, 28512
    s_add_u32 s31, s79, 11264
    buffer_load_dwordx4 v10, s[44:47], s31 offen lds
    s_add_u32 s78, s53, 0
    s_and_b32 s78, s78, 3
    s_lshl_b32 s49, s78, 20
    s_add_u32 m0, s30, 0
    s_add_u32 s31, s49, 0
    buffer_load_dwordx4 v2, s[40:43], s31 offen lds
    s_add_u32 m0, s30, 1056
    s_add_u32 s31, s49, 65536
    buffer_load_dwordx4 v2, s[40:43], s31 offen lds
    s_add_u32 m0, s30, 2112
    s_add_u32 s31, s49, 262144
    buffer_load_dwordx4 v2, s[40:43], s31 offen lds
    s_add_u32 m0, s30, 3168
    s_add_u32 s31, s49, 327680
    buffer_load_dwordx4 v2, s[40:43], s31 offen lds
    s_add_u32 m0, s30, 4224
    s_add_u32 s31, s49, 524288
    buffer_load_dwordx4 v2, s[40:43], s31 offen lds
    s_add_u32 m0, s30, 5280
    s_add_u32 s31, s49, 589824
    buffer_load_dwordx4 v2, s[40:43], s31 offen lds
    s_add_u32 m0, s30, 6336
    s_add_u32 s31, s49, 786432
    buffer_load_dwordx4 v2, s[40:43], s31 offen lds
    s_add_u32 m0, s30, 7392
    s_add_u32 s31, s49, 851968
    buffer_load_dwordx4 v2, s[40:43], s31 offen lds
    s_add_u32 s78, s53, 1
    s_and_b32 s78, s78, 3
    s_lshl_b32 s49, s78, 20
    s_add_u32 m0, s30, 8448
    s_add_u32 s31, s49, 0
    buffer_load_dwordx4 v2, s[40:43], s31 offen lds
    s_add_u32 m0, s30, 9504
    s_add_u32 s31, s49, 65536
    buffer_load_dwordx4 v2, s[40:43], s31 offen lds
    s_add_u32 m0, s30, 10560
    s_add_u32 s31, s49, 262144
    buffer_load_dwordx4 v2, s[40:43], s31 offen lds
    s_add_u32 m0, s30, 11616
    s_add_u32 s31, s49, 327680
    buffer_load_dwordx4 v2, s[40:43], s31 offen lds
    s_add_u32 m0, s30, 12672
    s_add_u32 s31, s49, 524288
    buffer_load_dwordx4 v2, s[40:43], s31 offen lds
    s_add_u32 m0, s30, 13728
    s_add_u32 s31, s49, 589824
    buffer_load_dwordx4 v2, s[40:43], s31 offen lds
    s_add_u32 m0, s30, 14784
    s_add_u32 s31, s49, 786432
    buffer_load_dwordx4 v2, s[40:43], s31 offen lds
    s_add_u32 m0, s30, 15840
    s_add_u32 s31, s49, 851968
    buffer_load_dwordx4 v2, s[40:43], s31 offen lds
    v_and_b32 v14, 15, v0
    v_add_u32 v14, 0, v14
    v_mul_u32_u24 v15, 43, v14
    v_lshrrev_b32 v15, 9, v15
    v_mul_u32_u24 v248, 22656, v15
    v_mul_u32_u24 v14, 1056, v14
    v_add_u32 v14, v14, v248
    v_lshrrev_b32 v15, 4, v0
    v_lshl_add_u32 v14, v15, 4, v14
    v_add_u32 v112, 16896, v14
    v_and_b32 v14, 15, v0
    v_add_u32 v14, 16, v14
    v_mul_u32_u24 v15, 43, v14
    v_lshrrev_b32 v15, 9, v15
    v_mul_u32_u24 v248, 22656, v15
    v_mul_u32_u24 v14, 1056, v14
    v_add_u32 v14, v14, v248
    v_lshrrev_b32 v15, 4, v0
    v_lshl_add_u32 v14, v15, 4, v14
    v_add_u32 v113, 16896, v14
    v_and_b32 v14, 15, v0
    v_add_u32 v14, 32, v14
    v_mul_u32_u24 v15, 43, v14
    v_lshrrev_b32 v15, 9, v15
    v_mul_u32_u24 v248, 22656, v15
    v_mul_u32_u24 v14, 1056, v14
    v_add_u32 v14, v14, v248
    v_lshrrev_b32 v15, 4, v0
    v_lshl_add_u32 v14, v15, 4, v14
    v_add_u32 v114, 16896, v14
    s_waitcnt vmcnt(16)
    s_barrier
    s_add_u32 s78, s53, 0
    s_and_b32 s78, s78, 3
    s_lshl_b32 s78, s78, 8
    v_add_u32 v115, s78, v112
    v_add_u32 v116, s78, v113
    v_add_u32 v117, s78, v114
    ds_read_b128 v[16:19], v115
    ds_read_b128 v[20:23], v116
    ds_read_b128 v[24:27], v117
    ds_read_b128 v[28:31], v115 offset:64
    ds_read_b128 v[32:35], v116 offset:64
    ds_read_b128 v[36:39], v117 offset:64
    ds_read_b128 v[40:43], v115 offset:128
    ds_read_b128 v[44:47], v116 offset:128
    ds_read_b128 v[48:51], v117 offset:128
    ds_read_b128 v[52:55], v115 offset:192
    ds_read_b128 v[56:59], v116 offset:192
    ds_read_b128 v[60:63], v117 offset:192
    s_waitcnt vmcnt(8)
    ds_read_b64_tr_b16 a[224:225], v3
    ds_read_b64_tr_b16 a[226:227], v3 offset:256
    ds_read_b64_tr_b16 a[228:229], v3 offset:32
    ds_read_b64_tr_b16 a[230:231], v3 offset:288
    ds_read_b64_tr_b16 a[232:233], v3 offset:2112
    ds_read_b64_tr_b16 a[234:235], v3 offset:2368
    ds_read_b64_tr_b16 a[236:237], v3 offset:2144
    ds_read_b64_tr_b16 a[238:239], v3 offset:2400
    ds_read_b64_tr_b16 a[240:241], v3 offset:4224
    ds_read_b64_tr_b16 a[242:243], v3 offset:4480
    ds_read_b64_tr_b16 a[244:245], v3 offset:4256
    ds_read_b64_tr_b16 a[246:247], v3 offset:4512
    ds_read_b64_tr_b16 a[248:249], v3 offset:6336
    ds_read_b64_tr_b16 a[250:251], v3 offset:6592
    ds_read_b64_tr_b16 a[252:253], v3 offset:6368
    ds_read_b64_tr_b16 a[254:255], v3 offset:6624
    s_waitcnt lgkmcnt(0)
    v_mfma_f32_16x16x32_bf16 a[0:3], a[224:227], v[16:19], 0
    s_add_u32 s78, s53, 2
    s_and_b32 s78, s78, 3
    s_lshl_b32 s49, s78, 20
    v_mfma_f32_16x16x32_bf16 a[4:7], a[224:227], v[20:23], 0
    s_add_u32 m0, s30, 0
    s_add_u32 s31, s49, 0
    buffer_load_dwordx4 v2, s[40:43], s31 offen lds
    v_mfma_f32_16x16x32_bf16 a[8:11], a[224:227], v[24:27], 0
    s_add_u32 m0, s30, 1056
    s_add_u32 s31, s49, 65536
    v_mfma_f32_16x16x32_bf16 a[12:15], a[228:231], v[16:19], 0
    buffer_load_dwordx4 v2, s[40:43], s31 offen lds
    s_add_u32 m0, s30, 2112
    s_add_u32 s31, s49, 262144
    v_mfma_f32_16x16x32_bf16 a[16:19], a[228:231], v[20:23], 0
    buffer_load_dwordx4 v2, s[40:43], s31 offen lds
    s_add_u32 m0, s30, 3168
    v_mfma_f32_16x16x32_bf16 a[20:23], a[228:231], v[24:27], 0
    s_add_u32 s31, s49, 327680
    buffer_load_dwordx4 v2, s[40:43], s31 offen lds
    s_add_u32 m0, s30, 4224
    v_mfma_f32_16x16x32_bf16 a[0:3], a[232:235], v[28:31], a[0:3]
    s_add_u32 s31, s49, 524288
    buffer_load_dwordx4 v2, s[40:43], s31 offen lds
    s_add_u32 m0, s30, 5280
    v_mfma_f32_16x16x32_bf16 a[4:7], a[232:235], v[32:35], a[4:7]
    s_add_u32 s31, s49, 589824
    buffer_load_dwordx4 v2, s[40:43], s31 offen lds
    v_mfma_f32_16x16x32_bf16 a[8:11], a[232:235], v[36:39], a[8:11]
    s_add_u32 m0, s30, 6336
    s_add_u32 s31, s49, 786432
    buffer_load_dwordx4 v2, s[40:43], s31 offen lds
    v_mfma_f32_16x16x32_bf16 a[12:15], a[236:239], v[28:31], a[12:15]
    s_add_u32 m0, s30, 7392
    s_add_u32 s31, s49, 851968
    v_mfma_f32_16x16x32_bf16 a[16:19], a[236:239], v[32:35], a[16:19]
    buffer_load_dwordx4 v2, s[40:43], s31 offen lds
    s_add_u32 s78, s53, 1
    s_and_b32 s78, s78, 3
    v_mfma_f32_16x16x32_bf16 a[20:23], a[236:239], v[36:39], a[20:23]
    s_lshl_b32 s78, s78, 8
    v_add_u32 v115, s78, v112
    v_mfma_f32_16x16x32_bf16 a[0:3], a[240:243], v[40:43], a[0:3]
    v_add_u32 v116, s78, v113
    v_add_u32 v117, s78, v114
    ds_read_b128 v[64:67], v115
    v_mfma_f32_16x16x32_bf16 a[4:7], a[240:243], v[44:47], a[4:7]
    ds_read_b128 v[68:71], v116
    ds_read_b128 v[72:75], v117
    ds_read_b128 v[76:79], v115 offset:64
    v_mfma_f32_16x16x32_bf16 a[8:11], a[240:243], v[48:51], a[8:11]
    ds_read_b128 v[80:83], v116 offset:64
    ds_read_b128 v[84:87], v117 offset:64
    v_mfma_f32_16x16x32_bf16 a[12:15], a[244:247], v[40:43], a[12:15]
    ds_read_b128 v[88:91], v115 offset:128
    ds_read_b128 v[92:95], v116 offset:128
    ds_read_b128 v[96:99], v117 offset:128
    v_mfma_f32_16x16x32_bf16 a[16:19], a[244:247], v[44:47], a[16:19]
    ds_read_b128 v[100:103], v115 offset:192
    ds_read_b128 v[104:107], v116 offset:192
    v_mfma_f32_16x16x32_bf16 a[20:23], a[244:247], v[48:51], a[20:23]
    ds_read_b128 v[108:111], v117 offset:192
    s_waitcnt vmcnt(8)
    ds_read_b64_tr_b16 a[192:193], v3 offset:8448
    v_mfma_f32_16x16x32_bf16 a[0:3], a[248:251], v[52:55], a[0:3]
    ds_read_b64_tr_b16 a[194:195], v3 offset:8704
    ds_read_b64_tr_b16 a[196:197], v3 offset:8480
    ds_read_b64_tr_b16 a[198:199], v3 offset:8736
    v_mfma_f32_16x16x32_bf16 a[4:7], a[248:251], v[56:59], a[4:7]
    ds_read_b64_tr_b16 a[200:201], v3 offset:10560
    ds_read_b64_tr_b16 a[202:203], v3 offset:10816
    v_mfma_f32_16x16x32_bf16 a[8:11], a[248:251], v[60:63], a[8:11]
    ds_read_b64_tr_b16 a[204:205], v3 offset:10592
    ds_read_b64_tr_b16 a[206:207], v3 offset:10848
    ds_read_b64_tr_b16 a[208:209], v3 offset:12672
    v_mfma_f32_16x16x32_bf16 a[12:15], a[252:255], v[52:55], a[12:15]
    ds_read_b64_tr_b16 a[210:211], v3 offset:12928
    ds_read_b64_tr_b16 a[212:213], v3 offset:12704
    v_mfma_f32_16x16x32_bf16 a[16:19], a[252:255], v[56:59], a[16:19]
    ds_read_b64_tr_b16 a[214:215], v3 offset:12960
    ds_read_b64_tr_b16 a[216:217], v3 offset:14784
    ds_read_b64_tr_b16 a[218:219], v3 offset:15040
    v_mfma_f32_16x16x32_bf16 a[20:23], a[252:255], v[60:63], a[20:23]
    ds_read_b64_tr_b16 a[220:221], v3 offset:14816
    ds_read_b64_tr_b16 a[222:223], v3 offset:15072
    s_waitcnt lgkmcnt(0)
    v_mfma_f32_16x16x32_bf16 a[0:3], a[192:195], v[64:67], a[0:3]
    s_add_u32 s78, s53, 3
    s_and_b32 s78, s78, 3
    s_lshl_b32 s49, s78, 20
    v_mfma_f32_16x16x32_bf16 a[4:7], a[192:195], v[68:71], a[4:7]
    s_add_u32 m0, s30, 8448
    s_add_u32 s31, s49, 0
    buffer_load_dwordx4 v2, s[40:43], s31 offen lds
    v_mfma_f32_16x16x32_bf16 a[8:11], a[192:195], v[72:75], a[8:11]
    s_add_u32 m0, s30, 9504
    s_add_u32 s31, s49, 65536
    v_mfma_f32_16x16x32_bf16 a[12:15], a[196:199], v[64:67], a[12:15]
    buffer_load_dwordx4 v2, s[40:43], s31 offen lds
    s_add_u32 m0, s30, 10560
    s_add_u32 s31, s49, 262144
    v_mfma_f32_16x16x32_bf16 a[16:19], a[196:199], v[68:71], a[16:19]
    buffer_load_dwordx4 v2, s[40:43], s31 offen lds
    s_add_u32 m0, s30, 11616
    v_mfma_f32_16x16x32_bf16 a[20:23], a[196:199], v[72:75], a[20:23]
    s_add_u32 s31, s49, 327680
    buffer_load_dwordx4 v2, s[40:43], s31 offen lds
    s_add_u32 m0, s30, 12672
    v_mfma_f32_16x16x32_bf16 a[0:3], a[200:203], v[76:79], a[0:3]
    s_add_u32 s31, s49, 524288
    buffer_load_dwordx4 v2, s[40:43], s31 offen lds
    s_add_u32 m0, s30, 13728
    v_mfma_f32_16x16x32_bf16 a[4:7], a[200:203], v[80:83], a[4:7]
    s_add_u32 s31, s49, 589824
    buffer_load_dwordx4 v2, s[40:43], s31 offen lds
    v_mfma_f32_16x16x32_bf16 a[8:11], a[200:203], v[84:87], a[8:11]
    s_add_u32 m0, s30, 14784
    s_add_u32 s31, s49, 786432
    buffer_load_dwordx4 v2, s[40:43], s31 offen lds
    v_mfma_f32_16x16x32_bf16 a[12:15], a[204:207], v[76:79], a[12:15]
    s_add_u32 m0, s30, 15840
    s_add_u32 s31, s49, 851968
    v_mfma_f32_16x16x32_bf16 a[16:19], a[204:207], v[80:83], a[16:19]
    buffer_load_dwordx4 v2, s[40:43], s31 offen lds
    s_add_u32 s78, s53, 2
    s_and_b32 s78, s78, 3
    v_mfma_f32_16x16x32_bf16 a[20:23], a[204:207], v[84:87], a[20:23]
    s_lshl_b32 s78, s78, 8
    v_add_u32 v115, s78, v112
    v_mfma_f32_16x16x32_bf16 a[0:3], a[208:211], v[88:91], a[0:3]
    v_add_u32 v116, s78, v113
    v_add_u32 v117, s78, v114
    ds_read_b128 v[16:19], v115
    v_mfma_f32_16x16x32_bf16 a[4:7], a[208:211], v[92:95], a[4:7]
    ds_read_b128 v[20:23], v116
    ds_read_b128 v[24:27], v117
    ds_read_b128 v[28:31], v115 offset:64
    v_mfma_f32_16x16x32_bf16 a[8:11], a[208:211], v[96:99], a[8:11]
    ds_read_b128 v[32:35], v116 offset:64
    ds_read_b128 v[36:39], v117 offset:64
    v_mfma_f32_16x16x32_bf16 a[12:15], a[212:215], v[88:91], a[12:15]
    ds_read_b128 v[40:43], v115 offset:128
    ds_read_b128 v[44:47], v116 offset:128
    ds_read_b128 v[48:51], v117 offset:128
    v_mfma_f32_16x16x32_bf16 a[16:19], a[212:215], v[92:95], a[16:19]
    ds_read_b128 v[52:55], v115 offset:192
    ds_read_b128 v[56:59], v116 offset:192
    v_mfma_f32_16x16x32_bf16 a[20:23], a[212:215], v[96:99], a[20:23]
    ds_read_b128 v[60:63], v117 offset:192
    s_waitcnt vmcnt(8)
    ds_read_b64_tr_b16 a[224:225], v3
    v_mfma_f32_16x16x32_bf16 a[0:3], a[216:219], v[100:103], a[0:3]
    ds_read_b64_tr_b16 a[226:227], v3 offset:256
    ds_read_b64_tr_b16 a[228:229], v3 offset:32
    ds_read_b64_tr_b16 a[230:231], v3 offset:288
    v_mfma_f32_16x16x32_bf16 a[4:7], a[216:219], v[104:107], a[4:7]
    ds_read_b64_tr_b16 a[232:233], v3 offset:2112
    ds_read_b64_tr_b16 a[234:235], v3 offset:2368
    v_mfma_f32_16x16x32_bf16 a[8:11], a[216:219], v[108:111], a[8:11]
    ds_read_b64_tr_b16 a[236:237], v3 offset:2144
    ds_read_b64_tr_b16 a[238:239], v3 offset:2400
    ds_read_b64_tr_b16 a[240:241], v3 offset:4224
    v_mfma_f32_16x16x32_bf16 a[12:15], a[220:223], v[100:103], a[12:15]
    ds_read_b64_tr_b16 a[242:243], v3 offset:4480
    ds_read_b64_tr_b16 a[244:245], v3 offset:4256
    v_mfma_f32_16x16x32_bf16 a[16:19], a[220:223], v[104:107], a[16:19]
    ds_read_b64_tr_b16 a[246:247], v3 offset:4512
    ds_read_b64_tr_b16 a[248:249], v3 offset:6336
    ds_read_b64_tr_b16 a[250:251], v3 offset:6592
    v_mfma_f32_16x16x32_bf16 a[20:23], a[220:223], v[108:111], a[20:23]
    ds_read_b64_tr_b16 a[252:253], v3 offset:6368
    ds_read_b64_tr_b16 a[254:255], v3 offset:6624
    s_waitcnt lgkmcnt(0)
    v_mfma_f32_16x16x32_bf16 a[0:3], a[224:227], v[16:19], a[0:3]
    s_add_u32 s78, s53, 0
    s_and_b32 s78, s78, 3
    s_lshl_b32 s49, s78, 20
    v_mfma_f32_16x16x32_bf16 a[4:7], a[224:227], v[20:23], a[4:7]
    s_add_u32 s49, s49, s100
    s_add_u32 m0, s30, 0
    s_add_u32 s31, s49, 0
    v_mfma_f32_16x16x32_bf16 a[8:11], a[224:227], v[24:27], a[8:11]
    buffer_load_dwordx4 v2, s[40:43], s31 offen lds
    s_add_u32 m0, s30, 1056
    v_mfma_f32_16x16x32_bf16 a[12:15], a[228:231], v[16:19], a[12:15]
    s_add_u32 s31, s49, 65536
    buffer_load_dwordx4 v2, s[40:43], s31 offen lds
    s_add_u32 m0, s30, 2112
    v_mfma_f32_16x16x32_bf16 a[16:19], a[228:231], v[20:23], a[16:19]
    s_add_u32 s31, s49, 262144
    buffer_load_dwordx4 v2, s[40:43], s31 offen lds
    s_add_u32 m0, s30, 3168
    v_mfma_f32_16x16x32_bf16 a[20:23], a[228:231], v[24:27], a[20:23]
    s_add_u32 s31, s49, 327680
    buffer_load_dwordx4 v2, s[40:43], s31 offen lds
    v_mfma_f32_16x16x32_bf16 a[0:3], a[232:235], v[28:31], a[0:3]
    s_add_u32 m0, s30, 4224
    s_add_u32 s31, s49, 524288
    buffer_load_dwordx4 v2, s[40:43], s31 offen lds
    v_mfma_f32_16x16x32_bf16 a[4:7], a[232:235], v[32:35], a[4:7]
    s_add_u32 m0, s30, 5280
    s_add_u32 s31, s49, 589824
    v_mfma_f32_16x16x32_bf16 a[8:11], a[232:235], v[36:39], a[8:11]
    buffer_load_dwordx4 v2, s[40:43], s31 offen lds
    s_add_u32 m0, s30, 6336
    s_add_u32 s31, s49, 786432
    v_mfma_f32_16x16x32_bf16 a[12:15], a[236:239], v[28:31], a[12:15]
    buffer_load_dwordx4 v2, s[40:43], s31 offen lds
    s_add_u32 m0, s30, 7392
    s_add_u32 s31, s49, 851968
    v_mfma_f32_16x16x32_bf16 a[16:19], a[236:239], v[32:35], a[16:19]
    buffer_load_dwordx4 v2, s[40:43], s31 offen lds
    s_add_u32 s78, s53, 3
    v_mfma_f32_16x16x32_bf16 a[20:23], a[236:239], v[36:39], a[20:23]
    s_and_b32 s78, s78, 3
    s_lshl_b32 s78, s78, 8
    v_add_u32 v115, s78, v112
    v_mfma_f32_16x16x32_bf16 a[0:3], a[240:243], v[40:43], a[0:3]
    v_add_u32 v116, s78, v113
    v_add_u32 v117, s78, v114
    ds_read_b128 v[64:67], v115
    v_mfma_f32_16x16x32_bf16 a[4:7], a[240:243], v[44:47], a[4:7]
    ds_read_b128 v[68:71], v116
    ds_read_b128 v[72:75], v117
    v_mfma_f32_16x16x32_bf16 a[8:11], a[240:243], v[48:51], a[8:11]
    ds_read_b128 v[76:79], v115 offset:64
    ds_read_b128 v[80:83], v116 offset:64
    ds_read_b128 v[84:87], v117 offset:64
    v_mfma_f32_16x16x32_bf16 a[12:15], a[244:247], v[40:43], a[12:15]
    ds_read_b128 v[88:91], v115 offset:128
    ds_read_b128 v[92:95], v116 offset:128
    v_mfma_f32_16x16x32_bf16 a[16:19], a[244:247], v[44:47], a[16:19]
    ds_read_b128 v[96:99], v117 offset:128
    ds_read_b128 v[100:103], v115 offset:192
    ds_read_b128 v[104:107], v116 offset:192
    v_mfma_f32_16x16x32_bf16 a[20:23], a[244:247], v[48:51], a[20:23]
    ds_read_b128 v[108:111], v117 offset:192
    s_waitcnt vmcnt(8)
    ds_read_b64_tr_b16 a[192:193], v3 offset:8448
    v_mfma_f32_16x16x32_bf16 a[0:3], a[248:251], v[52:55], a[0:3]
    ds_read_b64_tr_b16 a[194:195], v3 offset:8704
    ds_read_b64_tr_b16 a[196:197], v3 offset:8480
    v_mfma_f32_16x16x32_bf16 a[4:7], a[248:251], v[56:59], a[4:7]
    ds_read_b64_tr_b16 a[198:199], v3 offset:8736
    ds_read_b64_tr_b16 a[200:201], v3 offset:10560
    ds_read_b64_tr_b16 a[202:203], v3 offset:10816
    v_mfma_f32_16x16x32_bf16 a[8:11], a[248:251], v[60:63], a[8:11]
    ds_read_b64_tr_b16 a[204:205], v3 offset:10592
    ds_read_b64_tr_b16 a[206:207], v3 offset:10848
    ds_read_b64_tr_b16 a[208:209], v3 offset:12672
    v_mfma_f32_16x16x32_bf16 a[12:15], a[252:255], v[52:55], a[12:15]
    ds_read_b64_tr_b16 a[210:211], v3 offset:12928
    ds_read_b64_tr_b16 a[212:213], v3 offset:12704
    v_mfma_f32_16x16x32_bf16 a[16:19], a[252:255], v[56:59], a[16:19]
    ds_read_b64_tr_b16 a[214:215], v3 offset:12960
    ds_read_b64_tr_b16 a[216:217], v3 offset:14784
    ds_read_b64_tr_b16 a[218:219], v3 offset:15040
    v_mfma_f32_16x16x32_bf16 a[20:23], a[252:255], v[60:63], a[20:23]
    ds_read_b64_tr_b16 a[220:221], v3 offset:14816
    ds_read_b64_tr_b16 a[222:223], v3 offset:15072
    s_waitcnt lgkmcnt(0)
    v_mfma_f32_16x16x32_bf16 a[0:3], a[192:195], v[64:67], a[0:3]
    s_add_u32 s78, s53, 1
    s_and_b32 s78, s78, 3
    s_lshl_b32 s49, s78, 20
    v_mfma_f32_16x16x32_bf16 a[4:7], a[192:195], v[68:71], a[4:7]
    s_add_u32 s49, s49, s100
    s_add_u32 m0, s30, 8448
    s_add_u32 s31, s49, 0
    v_mfma_f32_16x16x32_bf16 a[8:11], a[192:195], v[72:75], a[8:11]
    buffer_load_dwordx4 v2, s[40:43], s31 offen lds
    s_add_u32 m0, s30, 9504
    v_mfma_f32_16x16x32_bf16 a[12:15], a[196:199], v[64:67], a[12:15]
    s_add_u32 s31, s49, 65536
    buffer_load_dwordx4 v2, s[40:43], s31 offen lds
    s_add_u32 m0, s30, 10560
    v_mfma_f32_16x16x32_bf16 a[16:19], a[196:199], v[68:71], a[16:19]
    s_add_u32 s31, s49, 262144
    buffer_load_dwordx4 v2, s[40:43], s31 offen lds
    s_add_u32 m0, s30, 11616
    v_mfma_f32_16x16x32_bf16 a[20:23], a[196:199], v[72:75], a[20:23]
    s_add_u32 s31, s49, 327680
    buffer_load_dwordx4 v2, s[40:43], s31 offen lds
    v_mfma_f32_16x16x32_bf16 a[0:3], a[200:203], v[76:79], a[0:3]
    s_add_u32 m0, s30, 12672
    s_add_u32 s31, s49, 524288
    buffer_load_dwordx4 v2, s[40:43], s31 offen lds
    v_mfma_f32_16x16x32_bf16 a[4:7], a[200:203], v[80:83], a[4:7]
    s_add_u32 m0, s30, 13728
    s_add_u32 s31, s49, 589824
    v_mfma_f32_16x16x32_bf16 a[8:11], a[200:203], v[84:87], a[8:11]
    buffer_load_dwordx4 v2, s[40:43], s31 offen lds
    s_add_u32 m0, s30, 14784
    s_add_u32 s31, s49, 786432
    v_mfma_f32_16x16x32_bf16 a[12:15], a[204:207], v[76:79], a[12:15]
    buffer_load_dwordx4 v2, s[40:43], s31 offen lds
    s_add_u32 m0, s30, 15840
    s_add_u32 s31, s49, 851968
    v_mfma_f32_16x16x32_bf16 a[16:19], a[204:207], v[80:83], a[16:19]
    buffer_load_dwordx4 v2, s[40:43], s31 offen lds
    s_add_u32 s78, s53, 0
    v_mfma_f32_16x16x32_bf16 a[20:23], a[204:207], v[84:87], a[20:23]
    s_and_b32 s78, s78, 3
    s_lshl_b32 s78, s78, 8
    v_add_u32 v115, s78, v112
    v_mfma_f32_16x16x32_bf16 a[0:3], a[208:211], v[88:91], a[0:3]
    v_add_u32 v116, s78, v113
    v_add_u32 v117, s78, v114
    ds_read_b128 v[16:19], v115
    v_mfma_f32_16x16x32_bf16 a[4:7], a[208:211], v[92:95], a[4:7]
    ds_read_b128 v[20:23], v116
    ds_read_b128 v[24:27], v117
    v_mfma_f32_16x16x32_bf16 a[8:11], a[208:211], v[96:99], a[8:11]
    ds_read_b128 v[28:31], v115 offset:64
    ds_read_b128 v[32:35], v116 offset:64
    ds_read_b128 v[36:39], v117 offset:64
    v_mfma_f32_16x16x32_bf16 a[12:15], a[212:215], v[88:91], a[12:15]
    ds_read_b128 v[40:43], v115 offset:128
    ds_read_b128 v[44:47], v116 offset:128
    v_mfma_f32_16x16x32_bf16 a[16:19], a[212:215], v[92:95], a[16:19]
    ds_read_b128 v[48:51], v117 offset:128
    ds_read_b128 v[52:55], v115 offset:192
    ds_read_b128 v[56:59], v116 offset:192
    v_mfma_f32_16x16x32_bf16 a[20:23], a[212:215], v[96:99], a[20:23]
    ds_read_b128 v[60:63], v117 offset:192
    s_waitcnt vmcnt(8)
    ds_read_b64_tr_b16 a[224:225], v3
    v_mfma_f32_16x16x32_bf16 a[0:3], a[216:219], v[100:103], a[0:3]
    ds_read_b64_tr_b16 a[226:227], v3 offset:256
    ds_read_b64_tr_b16 a[228:229], v3 offset:32
    v_mfma_f32_16x16x32_bf16 a[4:7], a[216:219], v[104:107], a[4:7]
    ds_read_b64_tr_b16 a[230:231], v3 offset:288
    ds_read_b64_tr_b16 a[232:233], v3 offset:2112
    ds_read_b64_tr_b16 a[234:235], v3 offset:2368
    v_mfma_f32_16x16x32_bf16 a[8:11], a[216:219], v[108:111], a[8:11]
    ds_read_b64_tr_b16 a[236:237], v3 offset:2144
    ds_read_b64_tr_b16 a[238:239], v3 offset:2400
    ds_read_b64_tr_b16 a[240:241], v3 offset:4224
    v_mfma_f32_16x16x32_bf16 a[12:15], a[220:223], v[100:103], a[12:15]
    ds_read_b64_tr_b16 a[242:243], v3 offset:4480
    ds_read_b64_tr_b16 a[244:245], v3 offset:4256
    v_mfma_f32_16x16x32_bf16 a[16:19], a[220:223], v[104:107], a[16:19]
    ds_read_b64_tr_b16 a[246:247], v3 offset:4512
    ds_read_b64_tr_b16 a[248:249], v3 offset:6336
    ds_read_b64_tr_b16 a[250:251], v3 offset:6592
    v_mfma_f32_16x16x32_bf16 a[20:23], a[220:223], v[108:111], a[20:23]
    ds_read_b64_tr_b16 a[252:253], v3 offset:6368
    ds_read_b64_tr_b16 a[254:255], v3 offset:6624
    s_waitcnt lgkmcnt(0)
    v_mfma_f32_16x16x32_bf16 a[96:99], a[224:227], v[16:19], 0
    s_add_u32 s78, s53, 2
    s_and_b32 s78, s78, 3
    s_lshl_b32 s49, s78, 20
    v_mfma_f32_16x16x32_bf16 a[100:103], a[224:227], v[20:23], 0
    s_add_u32 s49, s49, s100
    s_add_u32 m0, s30, 0
    s_add_u32 s31, s49, 0
    v_mfma_f32_16x16x32_bf16 a[104:107], a[224:227], v[24:27], 0
    buffer_load_dwordx4 v2, s[40:43], s31 offen lds
    s_add_u32 m0, s30, 1056
    v_mfma_f32_16x16x32_bf16 a[108:111], a[228:231], v[16:19], 0
    s_add_u32 s31, s49, 65536
    buffer_load_dwordx4 v2, s[40:43], s31 offen lds
    s_add_u32 m0, s30, 2112
    v_mfma_f32_16x16x32_bf16 a[112:115], a[228:231], v[20:23], 0
    s_add_u32 s31, s49, 262144
    buffer_load_dwordx4 v2, s[40:43], s31 offen lds
    s_add_u32 m0, s30, 3168
    v_mfma_f32_16x16x32_bf16 a[116:119], a[228:231], v[24:27], 0
    s_add_u32 s31, s49, 327680
    buffer_load_dwordx4 v2, s[40:43], s31 offen lds
    v_mfma_f32_16x16x32_bf16 a[96:99], a[232:235], v[28:31], a[96:99]
    s_add_u32 m0, s30, 4224
    s_add_u32 s31, s49, 524288
    buffer_load_dwordx4 v2, s[40:43], s31 offen lds
    v_mfma_f32_16x16x32_bf16 a[100:103], a[232:235], v[32:35], a[100:103]
    s_add_u32 m0, s30, 5280
    s_add_u32 s31, s49, 589824
    v_mfma_f32_16x16x32_bf16 a[104:107], a[232:235], v[36:39], a[104:107]
    buffer_load_dwordx4 v2, s[40:43], s31 offen lds
    s_add_u32 m0, s30, 6336
    s_add_u32 s31, s49, 786432
    v_mfma_f32_16x16x32_bf16 a[108:111], a[236:239], v[28:31], a[108:111]
    buffer_load_dwordx4 v2, s[40:43], s31 offen lds
    s_add_u32 m0, s30, 7392
    s_add_u32 s31, s49, 851968
    v_mfma_f32_16x16x32_bf16 a[112:115], a[236:239], v[32:35], a[112:115]
    buffer_load_dwordx4 v2, s[40:43], s31 offen lds
    s_add_u32 s78, s53, 1
    v_mfma_f32_16x16x32_bf16 a[116:119], a[236:239], v[36:39], a[116:119]
    s_and_b32 s78, s78, 3
    s_lshl_b32 s78, s78, 8
    v_add_u32 v115, s78, v112
    v_mfma_f32_16x16x32_bf16 a[96:99], a[240:243], v[40:43], a[96:99]
    v_add_u32 v116, s78, v113
    v_add_u32 v117, s78, v114
    ds_read_b128 v[64:67], v115
    v_mfma_f32_16x16x32_bf16 a[100:103], a[240:243], v[44:47], a[100:103]
    ds_read_b128 v[68:71], v116
    ds_read_b128 v[72:75], v117
    v_mfma_f32_16x16x32_bf16 a[104:107], a[240:243], v[48:51], a[104:107]
    ds_read_b128 v[76:79], v115 offset:64
    ds_read_b128 v[80:83], v116 offset:64
    ds_read_b128 v[84:87], v117 offset:64
    v_mfma_f32_16x16x32_bf16 a[108:111], a[244:247], v[40:43], a[108:111]
    ds_read_b128 v[88:91], v115 offset:128
    ds_read_b128 v[92:95], v116 offset:128
    v_mfma_f32_16x16x32_bf16 a[112:115], a[244:247], v[44:47], a[112:115]
    ds_read_b128 v[96:99], v117 offset:128
    ds_read_b128 v[100:103], v115 offset:192
    ds_read_b128 v[104:107], v116 offset:192
    v_mfma_f32_16x16x32_bf16 a[116:119], a[244:247], v[48:51], a[116:119]
    ds_read_b128 v[108:111], v117 offset:192
    s_waitcnt vmcnt(8)
    ds_read_b64_tr_b16 a[192:193], v3 offset:8448
    v_mfma_f32_16x16x32_bf16 a[96:99], a[248:251], v[52:55], a[96:99]
    ds_read_b64_tr_b16 a[194:195], v3 offset:8704
    ds_read_b64_tr_b16 a[196:197], v3 offset:8480
    v_mfma_f32_16x16x32_bf16 a[100:103], a[248:251], v[56:59], a[100:103]
    ds_read_b64_tr_b16 a[198:199], v3 offset:8736
    ds_read_b64_tr_b16 a[200:201], v3 offset:10560
    ds_read_b64_tr_b16 a[202:203], v3 offset:10816
    v_mfma_f32_16x16x32_bf16 a[104:107], a[248:251], v[60:63], a[104:107]
    ds_read_b64_tr_b16 a[204:205], v3 offset:10592
    ds_read_b64_tr_b16 a[206:207], v3 offset:10848
    ds_read_b64_tr_b16 a[208:209], v3 offset:12672
    v_mfma_f32_16x16x32_bf16 a[108:111], a[252:255], v[52:55], a[108:111]
    ds_read_b64_tr_b16 a[210:211], v3 offset:12928
    ds_read_b64_tr_b16 a[212:213], v3 offset:12704
    v_mfma_f32_16x16x32_bf16 a[112:115], a[252:255], v[56:59], a[112:115]
    ds_read_b64_tr_b16 a[214:215], v3 offset:12960
    ds_read_b64_tr_b16 a[216:217], v3 offset:14784
    ds_read_b64_tr_b16 a[218:219], v3 offset:15040
    v_mfma_f32_16x16x32_bf16 a[116:119], a[252:255], v[60:63], a[116:119]
    ds_read_b64_tr_b16 a[220:221], v3 offset:14816
    ds_read_b64_tr_b16 a[222:223], v3 offset:15072
    s_waitcnt lgkmcnt(0)
    v_mfma_f32_16x16x32_bf16 a[96:99], a[192:195], v[64:67], a[96:99]
    s_add_u32 s78, s53, 3
    s_and_b32 s78, s78, 3
    s_lshl_b32 s49, s78, 20
    v_mfma_f32_16x16x32_bf16 a[100:103], a[192:195], v[68:71], a[100:103]
    s_add_u32 s49, s49, s100
    s_add_u32 m0, s30, 8448
    s_add_u32 s31, s49, 0
    v_mfma_f32_16x16x32_bf16 a[104:107], a[192:195], v[72:75], a[104:107]
    buffer_load_dwordx4 v2, s[40:43], s31 offen lds
    s_add_u32 m0, s30, 9504
    v_mfma_f32_16x16x32_bf16 a[108:111], a[196:199], v[64:67], a[108:111]
    s_add_u32 s31, s49, 65536
    buffer_load_dwordx4 v2, s[40:43], s31 offen lds
    s_add_u32 m0, s30, 10560
    v_mfma_f32_16x16x32_bf16 a[112:115], a[196:199], v[68:71], a[112:115]
    s_add_u32 s31, s49, 262144
    buffer_load_dwordx4 v2, s[40:43], s31 offen lds
    s_add_u32 m0, s30, 11616
    v_mfma_f32_16x16x32_bf16 a[116:119], a[196:199], v[72:75], a[116:119]
    s_add_u32 s31, s49, 327680
    buffer_load_dwordx4 v2, s[40:43], s31 offen lds
    v_mfma_f32_16x16x32_bf16 a[96:99], a[200:203], v[76:79], a[96:99]
    s_add_u32 m0, s30, 12672
    s_add_u32 s31, s49, 524288
    buffer_load_dwordx4 v2, s[40:43], s31 offen lds
    v_mfma_f32_16x16x32_bf16 a[100:103], a[200:203], v[80:83], a[100:103]
    s_add_u32 m0, s30, 13728
    s_add_u32 s31, s49, 589824
    v_mfma_f32_16x16x32_bf16 a[104:107], a[200:203], v[84:87], a[104:107]
    buffer_load_dwordx4 v2, s[40:43], s31 offen lds
    s_add_u32 m0, s30, 14784
    s_add_u32 s31, s49, 786432
    v_mfma_f32_16x16x32_bf16 a[108:111], a[204:207], v[76:79], a[108:111]
    buffer_load_dwordx4 v2, s[40:43], s31 offen lds
    s_add_u32 m0, s30, 15840
    s_add_u32 s31, s49, 851968
    v_mfma_f32_16x16x32_bf16 a[112:115], a[204:207], v[80:83], a[112:115]
    buffer_load_dwordx4 v2, s[40:43], s31 offen lds
    s_add_u32 s78, s53, 2
    v_mfma_f32_16x16x32_bf16 a[116:119], a[204:207], v[84:87], a[116:119]
    s_and_b32 s78, s78, 3
    s_lshl_b32 s78, s78, 8
    v_add_u32 v115, s78, v112
    v_mfma_f32_16x16x32_bf16 a[96:99], a[208:211], v[88:91], a[96:99]
    v_add_u32 v116, s78, v113
    v_add_u32 v117, s78, v114
    ds_read_b128 v[16:19], v115
    v_mfma_f32_16x16x32_bf16 a[100:103], a[208:211], v[92:95], a[100:103]
    ds_read_b128 v[20:23], v116
    ds_read_b128 v[24:27], v117
    v_mfma_f32_16x16x32_bf16 a[104:107], a[208:211], v[96:99], a[104:107]
    ds_read_b128 v[28:31], v115 offset:64
    ds_read_b128 v[32:35], v116 offset:64
    ds_read_b128 v[36:39], v117 offset:64
    v_mfma_f32_16x16x32_bf16 a[108:111], a[212:215], v[88:91], a[108:111]
    ds_read_b128 v[40:43], v115 offset:128
    ds_read_b128 v[44:47], v116 offset:128
    v_mfma_f32_16x16x32_bf16 a[112:115], a[212:215], v[92:95], a[112:115]
    ds_read_b128 v[48:51], v117 offset:128
    ds_read_b128 v[52:55], v115 offset:192
    ds_read_b128 v[56:59], v116 offset:192
    v_mfma_f32_16x16x32_bf16 a[116:119], a[212:215], v[96:99], a[116:119]
    ds_read_b128 v[60:63], v117 offset:192
    s_waitcnt vmcnt(8)
    ds_read_b64_tr_b16 a[224:225], v3
    v_mfma_f32_16x16x32_bf16 a[96:99], a[216:219], v[100:103], a[96:99]
    ds_read_b64_tr_b16 a[226:227], v3 offset:256
    ds_read_b64_tr_b16 a[228:229], v3 offset:32
    v_mfma_f32_16x16x32_bf16 a[100:103], a[216:219], v[104:107], a[100:103]
    ds_read_b64_tr_b16 a[230:231], v3 offset:288
    ds_read_b64_tr_b16 a[232:233], v3 offset:2112
    ds_read_b64_tr_b16 a[234:235], v3 offset:2368
    v_mfma_f32_16x16x32_bf16 a[104:107], a[216:219], v[108:111], a[104:107]
    ds_read_b64_tr_b16 a[236:237], v3 offset:2144
    ds_read_b64_tr_b16 a[238:239], v3 offset:2400
    ds_read_b64_tr_b16 a[240:241], v3 offset:4224
    v_mfma_f32_16x16x32_bf16 a[108:111], a[220:223], v[100:103], a[108:111]
    ds_read_b64_tr_b16 a[242:243], v3 offset:4480
    ds_read_b64_tr_b16 a[244:245], v3 offset:4256
    v_mfma_f32_16x16x32_bf16 a[112:115], a[220:223], v[104:107], a[112:115]
    ds_read_b64_tr_b16 a[246:247], v3 offset:4512
    ds_read_b64_tr_b16 a[248:249], v3 offset:6336
    ds_read_b64_tr_b16 a[250:251], v3 offset:6592
    v_mfma_f32_16x16x32_bf16 a[116:119], a[220:223], v[108:111], a[116:119]
    ds_read_b64_tr_b16 a[252:253], v3 offset:6368
    ds_read_b64_tr_b16 a[254:255], v3 offset:6624
    s_waitcnt lgkmcnt(0)
    v_mfma_f32_16x16x32_bf16 a[96:99], a[224:227], v[16:19], a[96:99]
    s_mov_b32 s32, s68
    s_mov_b32 s33, s69
    s_mov_b32 s34, s77
    v_mfma_f32_16x16x32_bf16 a[100:103], a[224:227], v[20:23], a[100:103]
    s_mul_i32 s48, s1, 0
    s_mov_b32 s34, s0
    v_mfma_f32_16x16x32_bf16 a[104:107], a[224:227], v[24:27], a[104:107]
    s_add_u32 m0, s30, 0
    s_nop 0
    buffer_load_dwordx4 v1, s[32:35], s48 offen nt lds
    s_add_u32 m0, m0, 800
    v_mfma_f32_16x16x32_bf16 a[108:111], a[228:231], v[16:19], a[108:111]
    buffer_load_dwordx4 v1, s[32:35], s48 offen offset:256 nt lds
    s_add_u32 m0, m0, 800
    v_mfma_f32_16x16x32_bf16 a[112:115], a[228:231], v[20:23], a[112:115]
    buffer_load_dwordx4 v1, s[32:35], s48 offen offset:512 nt lds
    s_add_u32 m0, m0, 800
    v_mfma_f32_16x16x32_bf16 a[116:119], a[228:231], v[24:27], a[116:119]
    buffer_load_dwordx4 v1, s[32:35], s48 offen offset:768 nt lds
    s_add_u32 m0, m0, 800
    s_nop 0
    buffer_load_dwordx4 v1, s[32:35], s48 offen offset:1024 nt lds
    v_mfma_f32_16x16x32_bf16 a[96:99], a[232:235], v[28:31], a[96:99]
    s_add_u32 m0, m0, 800
    s_nop 0
    buffer_load_dwordx4 v1, s[32:35], s48 offen offset:1280 nt lds
    v_mfma_f32_16x16x32_bf16 a[100:103], a[232:235], v[32:35], a[100:103]
    s_add_u32 m0, m0, 800
    s_nop 0
    buffer_load_dwordx4 v1, s[32:35], s48 offen offset:1536 nt lds
    v_mfma_f32_16x16x32_bf16 a[104:107], a[232:235], v[36:39], a[104:107]
    s_add_u32 m0, m0, 800
    s_nop 0
    buffer_load_dwordx4 v1, s[32:35], s48 offen offset:1792 nt lds
    s_add_u32 s48, s48, s1
    v_mfma_f32_16x16x32_bf16 a[108:111], a[236:239], v[28:31], a[108:111]
    s_add_u32 s78, s53, 3
    s_and_b32 s78, s78, 3
    v_mfma_f32_16x16x32_bf16 a[112:115], a[236:239], v[32:35], a[112:115]
    s_lshl_b32 s78, s78, 8
    v_add_u32 v115, s78, v112
    v_add_u32 v116, s78, v113
    v_mfma_f32_16x16x32_bf16 a[116:119], a[236:239], v[36:39], a[116:119]
    v_add_u32 v117, s78, v114
    ds_read_b128 v[64:67], v115
    v_mfma_f32_16x16x32_bf16 a[96:99], a[240:243], v[40:43], a[96:99]
    ds_read_b128 v[68:71], v116
    ds_read_b128 v[72:75], v117
    v_mfma_f32_16x16x32_bf16 a[100:103], a[240:243], v[44:47], a[100:103]
    ds_read_b128 v[76:79], v115 offset:64
    ds_read_b128 v[80:83], v116 offset:64
    ds_read_b128 v[84:87], v117 offset:64
    v_mfma_f32_16x16x32_bf16 a[104:107], a[240:243], v[48:51], a[104:107]
    ds_read_b128 v[88:91], v115 offset:128
    ds_read_b128 v[92:95], v116 offset:128
    v_mfma_f32_16x16x32_bf16 a[108:111], a[244:247], v[40:43], a[108:111]
    ds_read_b128 v[96:99], v117 offset:128
    ds_read_b128 v[100:103], v115 offset:192
    v_mfma_f32_16x16x32_bf16 a[112:115], a[244:247], v[44:47], a[112:115]
    ds_read_b128 v[104:107], v116 offset:192
    ds_read_b128 v[108:111], v117 offset:192
    s_waitcnt vmcnt(8)
    v_mfma_f32_16x16x32_bf16 a[116:119], a[244:247], v[48:51], a[116:119]
    ds_read_b64_tr_b16 a[192:193], v3 offset:8448
    ds_read_b64_tr_b16 a[194:195], v3 offset:8704
    v_mfma_f32_16x16x32_bf16 a[96:99], a[248:251], v[52:55], a[96:99]
    ds_read_b64_tr_b16 a[196:197], v3 offset:8480
    ds_read_b64_tr_b16 a[198:199], v3 offset:8736
    ds_read_b64_tr_b16 a[200:201], v3 offset:10560
    v_mfma_f32_16x16x32_bf16 a[100:103], a[248:251], v[56:59], a[100:103]
    ds_read_b64_tr_b16 a[202:203], v3 offset:10816
    ds_read_b64_tr_b16 a[204:205], v3 offset:10592
    v_mfma_f32_16x16x32_bf16 a[104:107], a[248:251], v[60:63], a[104:107]
    ds_read_b64_tr_b16 a[206:207], v3 offset:10848
    ds_read_b64_tr_b16 a[208:209], v3 offset:12672
    v_mfma_f32_16x16x32_bf16 a[108:111], a[252:255], v[52:55], a[108:111]
    ds_read_b64_tr_b16 a[210:211], v3 offset:12928
    ds_read_b64_tr_b16 a[212:213], v3 offset:12704
    ds_read_b64_tr_b16 a[214:215], v3 offset:12960
    v_mfma_f32_16x16x32_bf16 a[112:115], a[252:255], v[56:59], a[112:115]
    ds_read_b64_tr_b16 a[216:217], v3 offset:14784
    ds_read_b64_tr_b16 a[218:219], v3 offset:15040
    v_mfma_f32_16x16x32_bf16 a[116:119], a[252:255], v[60:63], a[116:119]
    ds_read_b64_tr_b16 a[220:221], v3 offset:14816
    ds_read_b64_tr_b16 a[222:223], v3 offset:15072
    s_waitcnt lgkmcnt(0)
    v_mfma_f32_16x16x32_bf16 a[96:99], a[192:195], v[64:67], a[96:99]
    s_mov_b32 s32, s68
    v_mfma_f32_16x16x32_bf16 a[100:103], a[192:195], v[68:71], a[100:103]
    s_mov_b32 s33, s69
    v_mfma_f32_16x16x32_bf16 a[104:107], a[192:195], v[72:75], a[104:107]
    s_mov_b32 s34, s77
    v_mfma_f32_16x16x32_bf16 a[108:111], a[196:199], v[64:67], a[108:111]
    s_mul_i32 s48, s1, 1
    v_mfma_f32_16x16x32_bf16 a[112:115], a[196:199], v[68:71], a[112:115]
    s_mov_b32 s34, s0
    v_mfma_f32_16x16x32_bf16 a[116:119], a[196:199], v[72:75], a[116:119]
    s_add_u32 m0, s30, 8448
    v_mfma_f32_16x16x32_bf16 a[96:99], a[200:203], v[76:79], a[96:99]
    buffer_load_dwordx4 v1, s[32:35], s48 offen nt lds
    v_mfma_f32_16x16x32_bf16 a[100:103], a[200:203], v[80:83], a[100:103]
    s_add_u32 m0, m0, 800
    v_mfma_f32_16x16x32_bf16 a[104:107], a[200:203], v[84:87], a[104:107]
    buffer_load_dwordx4 v1, s[32:35], s48 offen offset:256 nt lds
    v_mfma_f32_16x16x32_bf16 a[108:111], a[204:207], v[76:79], a[108:111]
    s_add_u32 m0, m0, 800
    v_mfma_f32_16x16x32_bf16 a[112:115], a[204:207], v[80:83], a[112:115]
    buffer_load_dwordx4 v1, s[32:35], s48 offen offset:512 nt lds
    v_mfma_f32_16x16x32_bf16 a[116:119], a[204:207], v[84:87], a[116:119]
    v_mfma_f32_16x16x32_bf16 a[96:99], a[208:211], v[88:91], a[96:99]
    s_add_u32 m0, m0, 800
    v_mfma_f32_16x16x32_bf16 a[100:103], a[208:211], v[92:95], a[100:103]
    buffer_load_dwordx4 v1, s[32:35], s48 offen offset:768 nt lds
    v_mfma_f32_16x16x32_bf16 a[104:107], a[208:211], v[96:99], a[104:107]
    s_add_u32 m0, m0, 800
    v_mfma_f32_16x16x32_bf16 a[108:111], a[212:215], v[88:91], a[108:111]
    buffer_load_dwordx4 v1, s[32:35], s48 offen offset:1024 nt lds
    v_mfma_f32_16x16x32_bf16 a[112:115], a[212:215], v[92:95], a[112:115]
    s_add_u32 m0, m0, 800
    v_mfma_f32_16x16x32_bf16 a[116:119], a[212:215], v[96:99], a[116:119]
    buffer_load_dwordx4 v1, s[32:35], s48 offen offset:1280 nt lds
    v_mfma_f32_16x16x32_bf16 a[96:99], a[216:219], v[100:103], a[96:99]
    s_add_u32 m0, m0, 800
    v_mfma_f32_16x16x32_bf16 a[100:103], a[216:219], v[104:107], a[100:103]
    buffer_load_dwordx4 v1, s[32:35], s48 offen offset:1536 nt lds
    v_mfma_f32_16x16x32_bf16 a[104:107], a[216:219], v[108:111], a[104:107]
    s_add_u32 m0, m0, 800
    v_mfma_f32_16x16x32_bf16 a[108:111], a[220:223], v[100:103], a[108:111]
    buffer_load_dwordx4 v1, s[32:35], s48 offen offset:1792 nt lds
    v_mfma_f32_16x16x32_bf16 a[112:115], a[220:223], v[104:107], a[112:115]
    s_add_u32 s48, s48, s1
    v_mfma_f32_16x16x32_bf16 a[116:119], a[220:223], v[108:111], a[116:119]
    v_mov_b32 v14, 0
    global_load_dword v239, v14, s[26:27] sc1
    s_cmp_lg_u32 s56, 0
    s_cbranch_scc1 L_qp_ret
    s_lshl_b32 s31, s82, 2
    s_add_u32 s31, s31, s3
    s_lshl_b32 s31, s31, 11
    s_and_b32 s84, s81, 1
    v_and_b32 v14, 15, v0
    v_lshlrev_b32 v14, 7, v14
    v_bfe_u32 v15, v0, 4, 1
    s_lshl_b32 s78, s80, 2
    s_lshl_b32 s79, s84, 1
    s_add_u32 s78, s78, s79
    s_lshl_b32 s78, s78, 17
    s_add_u32 s78, s78, s31
    s_mov_b32 s32, s12
    s_mov_b32 s33, s13
    s_mov_b32 s34, 4194304
    v_mul_u32_u24 v248, 131072, v15
    v_add_u32 v248, v248, v14
    s_mov_b64 exec, 0xffffffff
    buffer_load_dword v245, v248, s[32:35], s78 offen
    s_mov_b64 exec, -1
    s_lshl_b32 s78, s80, 1
    s_lshl_b32 s79, s84, 0
    s_add_u32 s78, s78, s79
    s_lshl_b32 s78, s78, 17
    s_add_u32 s78, s78, s31
    s_mov_b32 s32, s22
    s_mov_b32 s33, s23
    s_mov_b32 s34, 4194304
    v_mul_u32_u24 v248, 2097152, v15
    v_add_u32 v248, v248, v14
    s_mov_b64 exec, 0xffffffff
    buffer_load_dword v245, v248, s[32:35], s78 offen
    s_mov_b64 exec, -1
    s_lshl_b32 s31, s84, 2
    s_add_u32 s31, s31, s3
    s_mul_i32 s31, s31, 6144
    s_mul_i32 s78, s82, 49152
    s_add_u32 s31, s31, s78
    s_cmp_eq_u32 s101, 0
    s_cselect_b32 s36, s14, s4
    s_cselect_b32 s37, s15, s5
    s_mov_b32 s38, 786432
    v_min_u32 v15, 47, v0
    v_lshlrev_b32 v15, 7, v15
    buffer_load_dword v244, v15, s[36:39], s31 offen
L_qp_ret:
    s_setpc_b64 s[60:61]
L_oppre:
    s_add_u32 m0, s30, 0
    s_mov_b32 s31, 0
    buffer_load_dwordx4 v5, s[40:43], s31 offen lds
    s_add_u32 m0, s30, 1056
    s_mov_b32 s31, 1024
    buffer_load_dwordx4 v5, s[40:43], s31 offen lds
    s_add_u32 m0, s30, 2112
    s_mov_b32 s31, 2048
    buffer_load_dwordx4 v5, s[40:43], s31 offen lds
    s_add_u32 m0, s30, 3168
    s_mov_b32 s31, 3072
    buffer_load_dwordx4 v5, s[40:43], s31 offen lds
    s_add_u32 m0, s30, 4224
    s_mov_b32 s31, 4096
    buffer_load_dwordx4 v5, s[40:43], s31 offen lds
    s_add_u32 m0, s30, 5280
    s_mov_b32 s31, 5120
    buffer_load_dwordx4 v5, s[40:43], s31 offen lds
    s_add_u32 m0, s30, 6336
    s_mov_b32 s31, 6144
    buffer_load_dwordx4 v5, s[40:43], s31 offen lds
    s_add_u32 m0, s30, 7392
    s_mov_b32 s31, 7168
    buffer_load_dwordx4 v5, s[40:43], s31 offen lds
    s_add_u32 m0, s30, 8448
    s_mov_b32 s31, 32768
    buffer_load_dwordx4 v5, s[40:43], s31 offen lds
    s_add_u32 m0, s30, 9504
    s_mov_b32 s31, 33792
    buffer_load_dwordx4 v5, s[40:43], s31 offen lds
    s_add_u32 m0, s30, 10560
    s_mov_b32 s31, 34816
    buffer_load_dwordx4 v5, s[40:43], s31 offen lds
    s_add_u32 m0, s30, 11616
    s_mov_b32 s31, 35840
    buffer_load_dwordx4 v5, s[40:43], s31 offen lds
    s_add_u32 m0, s30, 12672
    s_mov_b32 s31, 36864
    buffer_load_dwordx4 v5, s[40:43], s31 offen lds
    s_add_u32 m0, s30, 13728
    s_mov_b32 s31, 37888
    buffer_load_dwordx4 v5, s[40:43], s31 offen lds
    s_add_u32 m0, s30, 14784
    s_mov_b32 s31, 38912
    buffer_load_dwordx4 v5, s[40:43], s31 offen lds
    s_add_u32 m0, s30, 15840
    s_mov_b32 s31, 39936
    buffer_load_dwordx4 v5, s[40:43], s31 offen lds
    s_setpc_b64 s[60:61]
L_opart:
    s_waitcnt vmcnt(8)
    ds_read_b64_tr_b16 a[224:225], v8
    ds_read_b64_tr_b16 a[226:227], v8 offset:512
    ds_read_b64_tr_b16 a[228:229], v8 offset:32
    ds_read_b64_tr_b16 a[230:231], v8 offset:544
    ds_read_b64_tr_b16 a[232:233], v8 offset:64
    ds_read_b64_tr_b16 a[234:235], v8 offset:576
    ds_read_b64_tr_b16 a[236:237], v8 offset:96
    ds_read_b64_tr_b16 a[238:239], v8 offset:608
    ds_read_b64_tr_b16 a[240:241], v8 offset:128
    ds_read_b64_tr_b16 a[242:243], v8 offset:640
    ds_read_b64_tr_b16 a[244:245], v8 offset:160
    ds_read_b64_tr_b16 a[246:247], v8 offset:672
    ds_read_b64_tr_b16 a[248:249], v8 offset:192
    ds_read_b64_tr_b16 a[250:251], v8 offset:704
    ds_read_b64_tr_b16 a[252:253], v8 offset:224
    ds_read_b64_tr_b16 a[254:255], v8 offset:736
    s_waitcnt lgkmcnt(0)
    v_mfma_f32_16x16x32_bf16 a[0:3], a[224:227], v[140:143], 0
    s_add_u32 m0, s30, 0
    s_mov_b32 s31, 65536
    v_mfma_f32_16x16x32_bf16 a[12:15], a[228:231], v[140:143], 0
    buffer_load_dwordx4 v5, s[40:43], s31 offen lds
    s_add_u32 m0, s30, 1056
    v_mfma_f32_16x16x32_bf16 a[24:27], a[232:235], v[140:143], 0
    s_mov_b32 s31, 66560
    buffer_load_dwordx4 v5, s[40:43], s31 offen lds
    v_mfma_f32_16x16x32_bf16 a[36:39], a[236:239], v[140:143], 0
    s_add_u32 m0, s30, 2112
    v_mfma_f32_16x16x32_bf16 a[48:51], a[240:243], v[140:143], 0
    s_mov_b32 s31, 67584
    buffer_load_dwordx4 v5, s[40:43], s31 offen lds
    v_mfma_f32_16x16x32_bf16 a[60:63], a[244:247], v[140:143], 0
    s_add_u32 m0, s30, 3168
    s_mov_b32 s31, 68608
    v_mfma_f32_16x16x32_bf16 a[72:75], a[248:251], v[140:143], 0
    buffer_load_dwordx4 v5, s[40:43], s31 offen lds
    v_mfma_f32_16x16x32_bf16 a[84:87], a[252:255], v[140:143], 0
    s_add_u32 m0, s30, 4224
    s_mov_b32 s31, 69632
    v_mfma_f32_16x16x32_bf16 a[4:7], a[224:227], v[144:147], 0
    buffer_load_dwordx4 v5, s[40:43], s31 offen lds
    s_add_u32 m0, s30, 5280
    v_mfma_f32_16x16x32_bf16 a[16:19], a[228:231], v[144:147], 0
    s_mov_b32 s31, 70656
    buffer_load_dwordx4 v5, s[40:43], s31 offen lds
    v_mfma_f32_16x16x32_bf16 a[28:31], a[232:235], v[144:147], 0
    s_add_u32 m0, s30, 6336
    v_mfma_f32_16x16x32_bf16 a[40:43], a[236:239], v[144:147], 0
    s_mov_b32 s31, 71680
    buffer_load_dwordx4 v5, s[40:43], s31 offen lds
    v_mfma_f32_16x16x32_bf16 a[52:55], a[240:243], v[144:147], 0
    s_add_u32 m0, s30, 7392
    s_mov_b32 s31, 72704
    v_mfma_f32_16x16x32_bf16 a[64:67], a[244:247], v[144:147], 0
    buffer_load_dwordx4 v5, s[40:43], s31 offen lds
    v_mfma_f32_16x16x32_bf16 a[76:79], a[248:251], v[144:147], 0
    s_waitcnt vmcnt(8)
    ds_read_b64_tr_b16 a[192:193], v8 offset:8448
    v_mfma_f32_16x16x32_bf16 a[88:91], a[252:255], v[144:147], 0
    ds_read_b64_tr_b16 a[194:195], v8 offset:8960
    ds_read_b64_tr_b16 a[196:197], v8 offset:8480
    v_mfma_f32_16x16x32_bf16 a[8:11], a[224:227], v[148:151], 0
    ds_read_b64_tr_b16 a[198:199], v8 offset:8992
    ds_read_b64_tr_b16 a[200:201], v8 offset:8512
    v_mfma_f32_16x16x32_bf16 a[20:23], a[228:231], v[148:151], 0
    ds_read_b64_tr_b16 a[202:203], v8 offset:9024
    v_mfma_f32_16x16x32_bf16 a[32:35], a[232:235], v[148:151], 0
    ds_read_b64_tr_b16 a[204:205], v8 offset:8544
    ds_read_b64_tr_b16 a[206:207], v8 offset:9056
    v_mfma_f32_16x16x32_bf16 a[44:47], a[236:239], v[148:151], 0
    ds_read_b64_tr_b16 a[208:209], v8 offset:8576
    ds_read_b64_tr_b16 a[210:211], v8 offset:9088
    v_mfma_f32_16x16x32_bf16 a[56:59], a[240:243], v[148:151], 0
    ds_read_b64_tr_b16 a[212:213], v8 offset:8608
    v_mfma_f32_16x16x32_bf16 a[68:71], a[244:247], v[148:151], 0
    ds_read_b64_tr_b16 a[214:215], v8 offset:9120
    ds_read_b64_tr_b16 a[216:217], v8 offset:8640
    v_mfma_f32_16x16x32_bf16 a[80:83], a[248:251], v[148:151], 0
    ds_read_b64_tr_b16 a[218:219], v8 offset:9152
    ds_read_b64_tr_b16 a[220:221], v8 offset:8672
    v_mfma_f32_16x16x32_bf16 a[92:95], a[252:255], v[148:151], 0
    ds_read_b64_tr_b16 a[222:223], v8 offset:9184
    s_waitcnt lgkmcnt(0)
    v_mfma_f32_16x16x32_bf16 a[0:3], a[192:195], v[152:155], a[0:3]
    s_add_u32 m0, s30, 8448
    s_mov_b32 s31, 98304
    v_mfma_f32_16x16x32_bf16 a[12:15], a[196:199], v[152:155], a[12:15]
    buffer_load_dwordx4 v5, s[40:43], s31 offen lds
    s_add_u32 m0, s30, 9504
    v_mfma_f32_16x16x32_bf16 a[24:27], a[200:203], v[152:155], a[24:27]
    s_mov_b32 s31, 99328
    buffer_load_dwordx4 v5, s[40:43], s31 offen lds
    v_mfma_f32_16x16x32_bf16 a[36:39], a[204:207], v[152:155], a[36:39]
    s_add_u32 m0, s30, 10560
    v_mfma_f32_16x16x32_bf16 a[48:51], a[208:211], v[152:155], a[48:51]
    s_mov_b32 s31, 100352
    buffer_load_dwordx4 v5, s[40:43], s31 offen lds
    v_mfma_f32_16x16x32_bf16 a[60:63], a[212:215], v[152:155], a[60:63]
    s_add_u32 m0, s30, 11616
    s_mov_b32 s31, 101376
    v_mfma_f32_16x16x32_bf16 a[72:75], a[216:219], v[152:155], a[72:75]
    buffer_load_dwordx4 v5, s[40:43], s31 offen lds
    v_mfma_f32_16x16x32_bf16 a[84:87], a[220:223], v[152:155], a[84:87]
    s_add_u32 m0, s30, 12672
    s_mov_b32 s31, 102400
    v_mfma_f32_16x16x32_bf16 a[4:7], a[192:195], v[156:159], a[4:7]
    buffer_load_dwordx4 v5, s[40:43], s31 offen lds
    s_add_u32 m0, s30, 13728
    v_mfma_f32_16x16x32_bf16 a[16:19], a[196:199], v[156:159], a[16:19]
    s_mov_b32 s31, 103424
    buffer_load_dwordx4 v5, s[40:43], s31 offen lds
    v_mfma_f32_16x16x32_bf16 a[28:31], a[200:203], v[156:159], a[28:31]
    s_add_u32 m0, s30, 14784
    v_mfma_f32_16x16x32_bf16 a[40:43], a[204:207], v[156:159], a[40:43]
    s_mov_b32 s31, 104448
    buffer_load_dwordx4 v5, s[40:43], s31 offen lds
    v_mfma_f32_16x16x32_bf16 a[52:55], a[208:211], v[156:159], a[52:55]
    s_add_u32 m0, s30, 15840
    s_mov_b32 s31, 105472
    v_mfma_f32_16x16x32_bf16 a[64:67], a[212:215], v[156:159], a[64:67]
    buffer_load_dwordx4 v5, s[40:43], s31 offen lds
    v_mfma_f32_16x16x32_bf16 a[76:79], a[216:219], v[156:159], a[76:79]
    s_waitcnt vmcnt(8)
    ds_read_b64_tr_b16 a[224:225], v8
    v_mfma_f32_16x16x32_bf16 a[88:91], a[220:223], v[156:159], a[88:91]
    ds_read_b64_tr_b16 a[226:227], v8 offset:512
    ds_read_b64_tr_b16 a[228:229], v8 offset:32
    v_mfma_f32_16x16x32_bf16 a[8:11], a[192:195], v[160:163], a[8:11]
    ds_read_b64_tr_b16 a[230:231], v8 offset:544
    ds_read_b64_tr_b16 a[232:233], v8 offset:64
    v_mfma_f32_16x16x32_bf16 a[20:23], a[196:199], v[160:163], a[20:23]
    ds_read_b64_tr_b16 a[234:235], v8 offset:576
    v_mfma_f32_16x16x32_bf16 a[32:35], a[200:203], v[160:163], a[32:35]
    ds_read_b64_tr_b16 a[236:237], v8 offset:96
    ds_read_b64_tr_b16 a[238:239], v8 offset:608
    v_mfma_f32_16x16x32_bf16 a[44:47], a[204:207], v[160:163], a[44:47]
    ds_read_b64_tr_b16 a[240:241], v8 offset:128
    ds_read_b64_tr_b16 a[242:243], v8 offset:640
    v_mfma_f32_16x16x32_bf16 a[56:59], a[208:211], v[160:163], a[56:59]
    ds_read_b64_tr_b16 a[244:245], v8 offset:160
    v_mfma_f32_16x16x32_bf16 a[68:71], a[212:215], v[160:163], a[68:71]
    ds_read_b64_tr_b16 a[246:247], v8 offset:672
    ds_read_b64_tr_b16 a[248:249], v8 offset:192
    v_mfma_f32_16x16x32_bf16 a[80:83], a[216:219], v[160:163], a[80:83]
    ds_read_b64_tr_b16 a[250:251], v8 offset:704
    ds_read_b64_tr_b16 a[252:253], v8 offset:224
    v_mfma_f32_16x16x32_bf16 a[92:95], a[220:223], v[160:163], a[92:95]
    ds_read_b64_tr_b16 a[254:255], v8 offset:736
    s_waitcnt lgkmcnt(0)
    v_mfma_f32_16x16x32_bf16 a[0:3], a[224:227], v[164:167], a[0:3]
    s_add_u32 m0, s30, 0
    s_add_u32 s31, s57, 0
    v_mfma_f32_16x16x32_bf16 a[12:15], a[228:231], v[164:167], a[12:15]
    buffer_load_dwordx4 v5, s[40:43], s31 offen lds
    s_add_u32 m0, s30, 1056
    v_mfma_f32_16x16x32_bf16 a[24:27], a[232:235], v[164:167], a[24:27]
    s_add_u32 s31, s57, 1024
    buffer_load_dwordx4 v5, s[40:43], s31 offen lds
    v_mfma_f32_16x16x32_bf16 a[36:39], a[236:239], v[164:167], a[36:39]
    s_add_u32 m0, s30, 2112
    v_mfma_f32_16x16x32_bf16 a[48:51], a[240:243], v[164:167], a[48:51]
    s_add_u32 s31, s57, 2048
    buffer_load_dwordx4 v5, s[40:43], s31 offen lds
    v_mfma_f32_16x16x32_bf16 a[60:63], a[244:247], v[164:167], a[60:63]
    s_add_u32 m0, s30, 3168
    s_add_u32 s31, s57, 3072
    v_mfma_f32_16x16x32_bf16 a[72:75], a[248:251], v[164:167], a[72:75]
    buffer_load_dwordx4 v5, s[40:43], s31 offen lds
    v_mfma_f32_16x16x32_bf16 a[84:87], a[252:255], v[164:167], a[84:87]
    s_add_u32 m0, s30, 4224
    s_add_u32 s31, s57, 4096
    v_mfma_f32_16x16x32_bf16 a[4:7], a[224:227], v[168:171], a[4:7]
    buffer_load_dwordx4 v5, s[40:43], s31 offen lds
    s_add_u32 m0, s30, 5280
    v_mfma_f32_16x16x32_bf16 a[16:19], a[228:231], v[168:171], a[16:19]
    s_add_u32 s31, s57, 5120
    buffer_load_dwordx4 v5, s[40:43], s31 offen lds
    v_mfma_f32_16x16x32_bf16 a[28:31], a[232:235], v[168:171], a[28:31]
    s_add_u32 m0, s30, 6336
    v_mfma_f32_16x16x32_bf16 a[40:43], a[236:239], v[168:171], a[40:43]
    s_add_u32 s31, s57, 6144
    buffer_load_dwordx4 v5, s[40:43], s31 offen lds
    v_mfma_f32_16x16x32_bf16 a[52:55], a[240:243], v[168:171], a[52:55]
    s_add_u32 m0, s30, 7392
    s_add_u32 s31, s57, 7168
    v_mfma_f32_16x16x32_bf16 a[64:67], a[244:247], v[168:171], a[64:67]
    buffer_load_dwordx4 v5, s[40:43], s31 offen lds
    v_mfma_f32_16x16x32_bf16 a[76:79], a[248:251], v[168:171], a[76:79]
    s_waitcnt vmcnt(8)
    ds_read_b64_tr_b16 a[192:193], v8 offset:8448
    v_mfma_f32_16x16x32_bf16 a[88:91], a[252:255], v[168:171], a[88:91]
    ds_read_b64_tr_b16 a[194:195], v8 offset:8960
    ds_read_b64_tr_b16 a[196:197], v8 offset:8480
    v_mfma_f32_16x16x32_bf16 a[8:11], a[224:227], v[172:175], a[8:11]
    ds_read_b64_tr_b16 a[198:199], v8 offset:8992
    ds_read_b64_tr_b16 a[200:201], v8 offset:8512
    v_mfma_f32_16x16x32_bf16 a[20:23], a[228:231], v[172:175], a[20:23]
    ds_read_b64_tr_b16 a[202:203], v8 offset:9024
    v_mfma_f32_16x16x32_bf16 a[32:35], a[232:235], v[172:175], a[32:35]
    ds_read_b64_tr_b16 a[204:205], v8 offset:8544
    ds_read_b64_tr_b16 a[206:207], v8 offset:9056
    v_mfma_f32_16x16x32_bf16 a[44:47], a[236:239], v[172:175], a[44:47]
    ds_read_b64_tr_b16 a[208:209], v8 offset:8576
    ds_read_b64_tr_b16 a[210:211], v8 offset:9088
    v_mfma_f32_16x16x32_bf16 a[56:59], a[240:243], v[172:175], a[56:59]
    ds_read_b64_tr_b16 a[212:213], v8 offset:8608
    v_mfma_f32_16x16x32_bf16 a[68:71], a[244:247], v[172:175], a[68:71]
    ds_read_b64_tr_b16 a[214:215], v8 offset:9120
    ds_read_b64_tr_b16 a[216:217], v8 offset:8640
    v_mfma_f32_16x16x32_bf16 a[80:83], a[248:251], v[172:175], a[80:83]
    ds_read_b64_tr_b16 a[218:219], v8 offset:9152
    ds_read_b64_tr_b16 a[220:221], v8 offset:8672
    v_mfma_f32_16x16x32_bf16 a[92:95], a[252:255], v[172:175], a[92:95]
    ds_read_b64_tr_b16 a[222:223], v8 offset:9184
    s_waitcnt lgkmcnt(0)
    v_mfma_f32_16x16x32_bf16 a[0:3], a[192:195], v[176:179], a[0:3]
    s_add_u32 m0, s30, 8448
    s_add_u32 s31, s57, 32768
    v_mfma_f32_16x16x32_bf16 a[12:15], a[196:199], v[176:179], a[12:15]
    buffer_load_dwordx4 v5, s[40:43], s31 offen lds
    s_add_u32 m0, s30, 9504
    v_mfma_f32_16x16x32_bf16 a[24:27], a[200:203], v[176:179], a[24:27]
    s_add_u32 s31, s57, 33792
    buffer_load_dwordx4 v5, s[40:43], s31 offen lds
    v_mfma_f32_16x16x32_bf16 a[36:39], a[204:207], v[176:179], a[36:39]
    s_add_u32 m0, s30, 10560
    v_mfma_f32_16x16x32_bf16 a[48:51], a[208:211], v[176:179], a[48:51]
    s_add_u32 s31, s57, 34816
    buffer_load_dwordx4 v5, s[40:43], s31 offen lds
    v_mfma_f32_16x16x32_bf16 a[60:63], a[212:215], v[176:179], a[60:63]
    s_add_u32 m0, s30, 11616
    s_add_u32 s31, s57, 35840
    v_mfma_f32_16x16x32_bf16 a[72:75], a[216:219], v[176:179], a[72:75]
    buffer_load_dwordx4 v5, s[40:43], s31 offen lds
    v_mfma_f32_16x16x32_bf16 a[84:87], a[220:223], v[176:179], a[84:87]
    s_add_u32 m0, s30, 12672
    s_add_u32 s31, s57, 36864
    v_mfma_f32_16x16x32_bf16 a[4:7], a[192:195], v[180:183], a[4:7]
    buffer_load_dwordx4 v5, s[40:43], s31 offen lds
    s_add_u32 m0, s30, 13728
    v_mfma_f32_16x16x32_bf16 a[16:19], a[196:199], v[180:183], a[16:19]
    s_add_u32 s31, s57, 37888
    buffer_load_dwordx4 v5, s[40:43], s31 offen lds
    v_mfma_f32_16x16x32_bf16 a[28:31], a[200:203], v[180:183], a[28:31]
    s_add_u32 m0, s30, 14784
    v_mfma_f32_16x16x32_bf16 a[40:43], a[204:207], v[180:183], a[40:43]
    s_add_u32 s31, s57, 38912
    buffer_load_dwordx4 v5, s[40:43], s31 offen lds
    v_mfma_f32_16x16x32_bf16 a[52:55], a[208:211], v[180:183], a[52:55]
    s_add_u32 m0, s30, 15840
    s_add_u32 s31, s57, 39936
    v_mfma_f32_16x16x32_bf16 a[64:67], a[212:215], v[180:183], a[64:67]
    buffer_load_dwordx4 v5, s[40:43], s31 offen lds
    v_mfma_f32_16x16x32_bf16 a[76:79], a[216:219], v[180:183], a[76:79]
    s_waitcnt vmcnt(8)
    ds_read_b64_tr_b16 a[224:225], v8
    v_mfma_f32_16x16x32_bf16 a[88:91], a[220:223], v[180:183], a[88:91]
    ds_read_b64_tr_b16 a[226:227], v8 offset:512
    ds_read_b64_tr_b16 a[228:229], v8 offset:32
    v_mfma_f32_16x16x32_bf16 a[8:11], a[192:195], v[184:187], a[8:11]
    ds_read_b64_tr_b16 a[230:231], v8 offset:544
    ds_read_b64_tr_b16 a[232:233], v8 offset:64
    v_mfma_f32_16x16x32_bf16 a[20:23], a[196:199], v[184:187], a[20:23]
    ds_read_b64_tr_b16 a[234:235], v8 offset:576
    v_mfma_f32_16x16x32_bf16 a[32:35], a[200:203], v[184:187], a[32:35]
    ds_read_b64_tr_b16 a[236:237], v8 offset:96
    ds_read_b64_tr_b16 a[238:239], v8 offset:608
    v_mfma_f32_16x16x32_bf16 a[44:47], a[204:207], v[184:187], a[44:47]
    ds_read_b64_tr_b16 a[240:241], v8 offset:128
    ds_read_b64_tr_b16 a[242:243], v8 offset:640
    v_mfma_f32_16x16x32_bf16 a[56:59], a[208:211], v[184:187], a[56:59]
    ds_read_b64_tr_b16 a[244:245], v8 offset:160
    v_mfma_f32_16x16x32_bf16 a[68:71], a[212:215], v[184:187], a[68:71]
    ds_read_b64_tr_b16 a[246:247], v8 offset:672
    ds_read_b64_tr_b16 a[248:249], v8 offset:192
    v_mfma_f32_16x16x32_bf16 a[80:83], a[216:219], v[184:187], a[80:83]
    ds_read_b64_tr_b16 a[250:251], v8 offset:704
    ds_read_b64_tr_b16 a[252:253], v8 offset:224
    v_mfma_f32_16x16x32_bf16 a[92:95], a[220:223], v[184:187], a[92:95]
    ds_read_b64_tr_b16 a[254:255], v8 offset:736
    s_waitcnt lgkmcnt(0)
    v_mfma_f32_16x16x32_bf16 a[0:3], a[224:227], v[88:91], a[0:3]
    s_add_u32 m0, s30, 0
    s_add_u32 s31, s57, 65536
    v_mfma_f32_16x16x32_bf16 a[12:15], a[228:231], v[88:91], a[12:15]
    buffer_load_dwordx4 v5, s[40:43], s31 offen lds
    s_add_u32 m0, s30, 1056
    v_mfma_f32_16x16x32_bf16 a[24:27], a[232:235], v[88:91], a[24:27]
    s_add_u32 s31, s57, 66560
    buffer_load_dwordx4 v5, s[40:43], s31 offen lds
    v_mfma_f32_16x16x32_bf16 a[36:39], a[236:239], v[88:91], a[36:39]
    s_add_u32 m0, s30, 2112
    v_mfma_f32_16x16x32_bf16 a[48:51], a[240:243], v[88:91], a[48:51]
    s_add_u32 s31, s57, 67584
    buffer_load_dwordx4 v5, s[40:43], s31 offen lds
    v_mfma_f32_16x16x32_bf16 a[60:63], a[244:247], v[88:91], a[60:63]
    s_add_u32 m0, s30, 3168
    s_add_u32 s31, s57, 68608
    v_mfma_f32_16x16x32_bf16 a[72:75], a[248:251], v[88:91], a[72:75]
    buffer_load_dwordx4 v5, s[40:43], s31 offen lds
    v_mfma_f32_16x16x32_bf16 a[84:87], a[252:255], v[88:91], a[84:87]
    s_add_u32 m0, s30, 4224
    s_add_u32 s31, s57, 69632
    v_mfma_f32_16x16x32_bf16 a[4:7], a[224:227], v[92:95], a[4:7]
    buffer_load_dwordx4 v5, s[40:43], s31 offen lds
    s_add_u32 m0, s30, 5280
    v_mfma_f32_16x16x32_bf16 a[16:19], a[228:231], v[92:95], a[16:19]
    s_add_u32 s31, s57, 70656
    buffer_load_dwordx4 v5, s[40:43], s31 offen lds
    v_mfma_f32_16x16x32_bf16 a[28:31], a[232:235], v[92:95], a[28:31]
    s_add_u32 m0, s30, 6336
    v_mfma_f32_16x16x32_bf16 a[40:43], a[236:239], v[92:95], a[40:43]
    s_add_u32 s31, s57, 71680
    buffer_load_dwordx4 v5, s[40:43], s31 offen lds
    v_mfma_f32_16x16x32_bf16 a[52:55], a[240:243], v[92:95], a[52:55]
    s_add_u32 m0, s30, 7392
    s_add_u32 s31, s57, 72704
    v_mfma_f32_16x16x32_bf16 a[64:67], a[244:247], v[92:95], a[64:67]
    buffer_load_dwordx4 v5, s[40:43], s31 offen lds
    v_mfma_f32_16x16x32_bf16 a[76:79], a[248:251], v[92:95], a[76:79]
    s_waitcnt vmcnt(8)
    ds_read_b64_tr_b16 a[192:193], v8 offset:8448
    v_mfma_f32_16x16x32_bf16 a[88:91], a[252:255], v[92:95], a[88:91]
    ds_read_b64_tr_b16 a[194:195], v8 offset:8960
    ds_read_b64_tr_b16 a[196:197], v8 offset:8480
    v_mfma_f32_16x16x32_bf16 a[8:11], a[224:227], v[96:99], a[8:11]
    ds_read_b64_tr_b16 a[198:199], v8 offset:8992
    ds_read_b64_tr_b16 a[200:201], v8 offset:8512
    v_mfma_f32_16x16x32_bf16 a[20:23], a[228:231], v[96:99], a[20:23]
    ds_read_b64_tr_b16 a[202:203], v8 offset:9024
    v_mfma_f32_16x16x32_bf16 a[32:35], a[232:235], v[96:99], a[32:35]
    ds_read_b64_tr_b16 a[204:205], v8 offset:8544
    ds_read_b64_tr_b16 a[206:207], v8 offset:9056
    v_mfma_f32_16x16x32_bf16 a[44:47], a[236:239], v[96:99], a[44:47]
    ds_read_b64_tr_b16 a[208:209], v8 offset:8576
    ds_read_b64_tr_b16 a[210:211], v8 offset:9088
    v_mfma_f32_16x16x32_bf16 a[56:59], a[240:243], v[96:99], a[56:59]
    ds_read_b64_tr_b16 a[212:213], v8 offset:8608
    v_mfma_f32_16x16x32_bf16 a[68:71], a[244:247], v[96:99], a[68:71]
    ds_read_b64_tr_b16 a[214:215], v8 offset:9120
    ds_read_b64_tr_b16 a[216:217], v8 offset:8640
    v_mfma_f32_16x16x32_bf16 a[80:83], a[248:251], v[96:99], a[80:83]
    ds_read_b64_tr_b16 a[218:219], v8 offset:9152
    ds_read_b64_tr_b16 a[220:221], v8 offset:8672
    v_mfma_f32_16x16x32_bf16 a[92:95], a[252:255], v[96:99], a[92:95]
    ds_read_b64_tr_b16 a[222:223], v8 offset:9184
    s_waitcnt lgkmcnt(0)
    v_mfma_f32_16x16x32_bf16 a[0:3], a[192:195], v[100:103], a[0:3]
    s_add_u32 m0, s30, 8448
    s_add_u32 s31, s57, 98304
    v_mfma_f32_16x16x32_bf16 a[12:15], a[196:199], v[100:103], a[12:15]
    buffer_load_dwordx4 v5, s[40:43], s31 offen lds
    s_add_u32 m0, s30, 9504
    v_mfma_f32_16x16x32_bf16 a[24:27], a[200:203], v[100:103], a[24:27]
    s_add_u32 s31, s57, 99328
    buffer_load_dwordx4 v5, s[40:43], s31 offen lds
    v_mfma_f32_16x16x32_bf16 a[36:39], a[204:207], v[100:103], a[36:39]
    s_add_u32 m0, s30, 10560
    v_mfma_f32_16x16x32_bf16 a[48:51], a[208:211], v[100:103], a[48:51]
    s_add_u32 s31, s57, 100352
    buffer_load_dwordx4 v5, s[40:43], s31 offen lds
    v_mfma_f32_16x16x32_bf16 a[60:63], a[212:215], v[100:103], a[60:63]
    s_add_u32 m0, s30, 11616
    s_add_u32 s31, s57, 101376
    v_mfma_f32_16x16x32_bf16 a[72:75], a[216:219], v[100:103], a[72:75]
    buffer_load_dwordx4 v5, s[40:43], s31 offen lds
    v_mfma_f32_16x16x32_bf16 a[84:87], a[220:223], v[100:103], a[84:87]
    s_add_u32 m0, s30, 12672
    s_add_u32 s31, s57, 102400
    v_mfma_f32_16x16x32_bf16 a[4:7], a[192:195], v[104:107], a[4:7]
    buffer_load_dwordx4 v5, s[40:43], s31 offen lds
    s_add_u32 m0, s30, 13728
    v_mfma_f32_16x16x32_bf16 a[16:19], a[196:199], v[104:107], a[16:19]
    s_add_u32 s31, s57, 103424
    buffer_load_dwordx4 v5, s[40:43], s31 offen lds
    v_mfma_f32_16x16x32_bf16 a[28:31], a[200:203], v[104:107], a[28:31]
    s_add_u32 m0, s30, 14784
    v_mfma_f32_16x16x32_bf16 a[40:43], a[204:207], v[104:107], a[40:43]
    s_add_u32 s31, s57, 104448
    buffer_load_dwordx4 v5, s[40:43], s31 offen lds
    v_mfma_f32_16x16x32_bf16 a[52:55], a[208:211], v[104:107], a[52:55]
    s_add_u32 m0, s30, 15840
    s_add_u32 s31, s57, 105472
    v_mfma_f32_16x16x32_bf16 a[64:67], a[212:215], v[104:107], a[64:67]
    buffer_load_dwordx4 v5, s[40:43], s31 offen lds
    v_mfma_f32_16x16x32_bf16 a[76:79], a[216:219], v[104:107], a[76:79]
    s_waitcnt vmcnt(8)
    ds_read_b64_tr_b16 a[224:225], v8
    v_mfma_f32_16x16x32_bf16 a[88:91], a[220:223], v[104:107], a[88:91]
    ds_read_b64_tr_b16 a[226:227], v8 offset:512
    ds_read_b64_tr_b16 a[228:229], v8 offset:32
    v_mfma_f32_16x16x32_bf16 a[8:11], a[192:195], v[108:111], a[8:11]
    ds_read_b64_tr_b16 a[230:231], v8 offset:544
    ds_read_b64_tr_b16 a[232:233], v8 offset:64
    v_mfma_f32_16x16x32_bf16 a[20:23], a[196:199], v[108:111], a[20:23]
    ds_read_b64_tr_b16 a[234:235], v8 offset:576
    v_mfma_f32_16x16x32_bf16 a[32:35], a[200:203], v[108:111], a[32:35]
    ds_read_b64_tr_b16 a[236:237], v8 offset:96
    ds_read_b64_tr_b16 a[238:239], v8 offset:608
    v_mfma_f32_16x16x32_bf16 a[44:47], a[204:207], v[108:111], a[44:47]
    ds_read_b64_tr_b16 a[240:241], v8 offset:128
    ds_read_b64_tr_b16 a[242:243], v8 offset:640
    v_mfma_f32_16x16x32_bf16 a[56:59], a[208:211], v[108:111], a[56:59]
    ds_read_b64_tr_b16 a[244:245], v8 offset:160
    v_mfma_f32_16x16x32_bf16 a[68:71], a[212:215], v[108:111], a[68:71]
    ds_read_b64_tr_b16 a[246:247], v8 offset:672
    ds_read_b64_tr_b16 a[248:249], v8 offset:192
    v_mfma_f32_16x16x32_bf16 a[80:83], a[216:219], v[108:111], a[80:83]
    ds_read_b64_tr_b16 a[250:251], v8 offset:704
    ds_read_b64_tr_b16 a[252:253], v8 offset:224
    v_mfma_f32_16x16x32_bf16 a[92:95], a[220:223], v[108:111], a[92:95]
    ds_read_b64_tr_b16 a[254:255], v8 offset:736
    s_waitcnt lgkmcnt(0)
    v_mfma_f32_16x16x32_bf16 a[0:3], a[224:227], v[112:115], a[0:3]
    s_waitcnt vmcnt(0)
    v_mfma_f32_16x16x32_bf16 a[12:15], a[228:231], v[112:115], a[12:15]
    ds_read_b64_tr_b16 a[192:193], v8 offset:8448
    v_mfma_f32_16x16x32_bf16 a[24:27], a[232:235], v[112:115], a[24:27]
    ds_read_b64_tr_b16 a[194:195], v8 offset:8960
    v_mfma_f32_16x16x32_bf16 a[36:39], a[236:239], v[112:115], a[36:39]
    v_mfma_f32_16x16x32_bf16 a[48:51], a[240:243], v[112:115], a[48:51]
    ds_read_b64_tr_b16 a[196:197], v8 offset:8480
    v_mfma_f32_16x16x32_bf16 a[60:63], a[244:247], v[112:115], a[60:63]
    ds_read_b64_tr_b16 a[198:199], v8 offset:8992
    v_mfma_f32_16x16x32_bf16 a[72:75], a[248:251], v[112:115], a[72:75]
    v_mfma_f32_16x16x32_bf16 a[84:87], a[252:255], v[112:115], a[84:87]
    ds_read_b64_tr_b16 a[200:201], v8 offset:8512
    v_mfma_f32_16x16x32_bf16 a[4:7], a[224:227], v[116:119], a[4:7]
    ds_read_b64_tr_b16 a[202:203], v8 offset:9024
    v_mfma_f32_16x16x32_bf16 a[16:19], a[228:231], v[116:119], a[16:19]
    ds_read_b64_tr_b16 a[204:205], v8 offset:8544
    v_mfma_f32_16x16x32_bf16 a[28:31], a[232:235], v[116:119], a[28:31]
    v_mfma_f32_16x16x32_bf16 a[40:43], a[236:239], v[116:119], a[40:43]
    ds_read_b64_tr_b16 a[206:207], v8 offset:9056
    v_mfma_f32_16x16x32_bf16 a[52:55], a[240:243], v[116:119], a[52:55]
    ds_read_b64_tr_b16 a[208:209], v8 offset:8576
    v_mfma_f32_16x16x32_bf16 a[64:67], a[244:247], v[116:119], a[64:67]
    v_mfma_f32_16x16x32_bf16 a[76:79], a[248:251], v[116:119], a[76:79]
    ds_read_b64_tr_b16 a[210:211], v8 offset:9088
    v_mfma_f32_16x16x32_bf16 a[88:91], a[252:255], v[116:119], a[88:91]
    ds_read_b64_tr_b16 a[212:213], v8 offset:8608
    v_mfma_f32_16x16x32_bf16 a[8:11], a[224:227], v[120:123], a[8:11]
    ds_read_b64_tr_b16 a[214:215], v8 offset:9120
    v_mfma_f32_16x16x32_bf16 a[20:23], a[228:231], v[120:123], a[20:23]
    v_mfma_f32_16x16x32_bf16 a[32:35], a[232:235], v[120:123], a[32:35]
    ds_read_b64_tr_b16 a[216:217], v8 offset:8640
    v_mfma_f32_16x16x32_bf16 a[44:47], a[236:239], v[120:123], a[44:47]
    ds_read_b64_tr_b16 a[218:219], v8 offset:9152
    v_mfma_f32_16x16x32_bf16 a[56:59], a[240:243], v[120:123], a[56:59]
    v_mfma_f32_16x16x32_bf16 a[68:71], a[244:247], v[120:123], a[68:71]
    ds_read_b64_tr_b16 a[220:221], v8 offset:8672
    v_mfma_f32_16x16x32_bf16 a[80:83], a[248:251], v[120:123], a[80:83]
    ds_read_b64_tr_b16 a[222:223], v8 offset:9184
    v_mfma_f32_16x16x32_bf16 a[92:95], a[252:255], v[120:123], a[92:95]
    s_waitcnt lgkmcnt(0)
    v_mfma_f32_16x16x32_bf16 a[0:3], a[192:195], v[124:127], a[0:3]
    v_mfma_f32_16x16x32_bf16 a[12:15], a[196:199], v[124:127], a[12:15]
    v_mfma_f32_16x16x32_bf16 a[24:27], a[200:203], v[124:127], a[24:27]
    v_mfma_f32_16x16x32_bf16 a[36:39], a[204:207], v[124:127], a[36:39]
    v_mfma_f32_16x16x32_bf16 a[48:51], a[208:211], v[124:127], a[48:51]
    v_mfma_f32_16x16x32_bf16 a[60:63], a[212:215], v[124:127], a[60:63]
    v_mfma_f32_16x16x32_bf16 a[72:75], a[216:219], v[124:127], a[72:75]
    v_mfma_f32_16x16x32_bf16 a[84:87], a[220:223], v[124:127], a[84:87]
    v_mfma_f32_16x16x32_bf16 a[4:7], a[192:195], v[128:131], a[4:7]
    v_mfma_f32_16x16x32_bf16 a[16:19], a[196:199], v[128:131], a[16:19]
    v_mfma_f32_16x16x32_bf16 a[28:31], a[200:203], v[128:131], a[28:31]
    v_mfma_f32_16x16x32_bf16 a[40:43], a[204:207], v[128:131], a[40:43]
    v_mfma_f32_16x16x32_bf16 a[52:55], a[208:211], v[128:131], a[52:55]
    v_mfma_f32_16x16x32_bf16 a[64:67], a[212:215], v[128:131], a[64:67]
    v_mfma_f32_16x16x32_bf16 a[76:79], a[216:219], v[128:131], a[76:79]
    v_mfma_f32_16x16x32_bf16 a[88:91], a[220:223], v[128:131], a[88:91]
    v_mfma_f32_16x16x32_bf16 a[8:11], a[192:195], v[132:135], a[8:11]
    v_mfma_f32_16x16x32_bf16 a[20:23], a[196:199], v[132:135], a[20:23]
    v_mfma_f32_16x16x32_bf16 a[32:35], a[200:203], v[132:135], a[32:35]
    v_mfma_f32_16x16x32_bf16 a[44:47], a[204:207], v[132:135], a[44:47]
    v_mfma_f32_16x16x32_bf16 a[56:59], a[208:211], v[132:135], a[56:59]
    v_mfma_f32_16x16x32_bf16 a[68:71], a[212:215], v[132:135], a[68:71]
    v_mfma_f32_16x16x32_bf16 a[80:83], a[216:219], v[132:135], a[80:83]
    v_mfma_f32_16x16x32_bf16 a[92:95], a[220:223], v[132:135], a[92:95]
    s_nop 7
    v_accvgpr_read_b32 v248, a0
    v_accvgpr_read_b32 v249, a1
    v_accvgpr_read_b32 v250, a2
    v_accvgpr_read_b32 v251, a3
    v_cvt_pk_bf16_f32 v16, v248, v249
    v_cvt_pk_bf16_f32 v17, v250, v251
    v_accvgpr_read_b32 v248, a12
    v_accvgpr_read_b32 v249, a13
    v_accvgpr_read_b32 v250, a14
    v_accvgpr_read_b32 v251, a15
    v_cvt_pk_bf16_f32 v18, v248, v249
    v_cvt_pk_bf16_f32 v19, v250, v251
    s_add_u32 s78, s67, 0
    buffer_store_dwordx4 v[16:19], v10, s[96:99], s78 offen sc1
    v_accvgpr_read_b32 v248, a4
    v_accvgpr_read_b32 v249, a5
    v_accvgpr_read_b32 v250, a6
    v_accvgpr_read_b32 v251, a7
    v_cvt_pk_bf16_f32 v20, v248, v249
    v_cvt_pk_bf16_f32 v21, v250, v251
    v_accvgpr_read_b32 v248, a16
    v_accvgpr_read_b32 v249, a17
    v_accvgpr_read_b32 v250, a18
    v_accvgpr_read_b32 v251, a19
    v_cvt_pk_bf16_f32 v22, v248, v249
    v_cvt_pk_bf16_f32 v23, v250, v251
    buffer_store_dwordx4 v[20:23], v10, s[96:99], s78 offen offset:1024 sc1
    v_accvgpr_read_b32 v248, a8
    v_accvgpr_read_b32 v249, a9
    v_accvgpr_read_b32 v250, a10
    v_accvgpr_read_b32 v251, a11
    v_cvt_pk_bf16_f32 v24, v248, v249
    v_cvt_pk_bf16_f32 v25, v250, v251
    v_accvgpr_read_b32 v248, a20
    v_accvgpr_read_b32 v249, a21
    v_accvgpr_read_b32 v250, a22
    v_accvgpr_read_b32 v251, a23
    v_cvt_pk_bf16_f32 v26, v248, v249
    v_cvt_pk_bf16_f32 v27, v250, v251
    buffer_store_dwordx4 v[24:27], v10, s[96:99], s78 offen offset:2048 sc1
    v_accvgpr_read_b32 v248, a24
    v_accvgpr_read_b32 v249, a25
    v_accvgpr_read_b32 v250, a26
    v_accvgpr_read_b32 v251, a27
    v_cvt_pk_bf16_f32 v28, v248, v249
    v_cvt_pk_bf16_f32 v29, v250, v251
    v_accvgpr_read_b32 v248, a36
    v_accvgpr_read_b32 v249, a37
    v_accvgpr_read_b32 v250, a38
    v_accvgpr_read_b32 v251, a39
    v_cvt_pk_bf16_f32 v30, v248, v249
    v_cvt_pk_bf16_f32 v31, v250, v251
    buffer_store_dwordx4 v[28:31], v10, s[96:99], s78 offen offset:3072 sc1
    v_accvgpr_read_b32 v248, a28
    v_accvgpr_read_b32 v249, a29
    v_accvgpr_read_b32 v250, a30
    v_accvgpr_read_b32 v251, a31
    v_cvt_pk_bf16_f32 v32, v248, v249
    v_cvt_pk_bf16_f32 v33, v250, v251
    v_accvgpr_read_b32 v248, a40
    v_accvgpr_read_b32 v249, a41
    v_accvgpr_read_b32 v250, a42
    v_accvgpr_read_b32 v251, a43
    v_cvt_pk_bf16_f32 v34, v248, v249
    v_cvt_pk_bf16_f32 v35, v250, v251
    s_add_u32 s78, s67, 4096
    buffer_store_dwordx4 v[32:35], v10, s[96:99], s78 offen sc1
    v_accvgpr_read_b32 v248, a32
    v_accvgpr_read_b32 v249, a33
    v_accvgpr_read_b32 v250, a34
    v_accvgpr_read_b32 v251, a35
    v_cvt_pk_bf16_f32 v36, v248, v249
    v_cvt_pk_bf16_f32 v37, v250, v251
    v_accvgpr_read_b32 v248, a44
    v_accvgpr_read_b32 v249, a45
    v_accvgpr_read_b32 v250, a46
    v_accvgpr_read_b32 v251, a47
    v_cvt_pk_bf16_f32 v38, v248, v249
    v_cvt_pk_bf16_f32 v39, v250, v251
    buffer_store_dwordx4 v[36:39], v10, s[96:99], s78 offen offset:1024 sc1
    v_accvgpr_read_b32 v248, a48
    v_accvgpr_read_b32 v249, a49
    v_accvgpr_read_b32 v250, a50
    v_accvgpr_read_b32 v251, a51
    v_cvt_pk_bf16_f32 v16, v248, v249
    v_cvt_pk_bf16_f32 v17, v250, v251
    v_accvgpr_read_b32 v248, a60
    v_accvgpr_read_b32 v249, a61
    v_accvgpr_read_b32 v250, a62
    v_accvgpr_read_b32 v251, a63
    v_cvt_pk_bf16_f32 v18, v248, v249
    v_cvt_pk_bf16_f32 v19, v250, v251
    buffer_store_dwordx4 v[16:19], v10, s[96:99], s78 offen offset:2048 sc1
    v_accvgpr_read_b32 v248, a52
    v_accvgpr_read_b32 v249, a53
    v_accvgpr_read_b32 v250, a54
    v_accvgpr_read_b32 v251, a55
    v_cvt_pk_bf16_f32 v20, v248, v249
    v_cvt_pk_bf16_f32 v21, v250, v251
    v_accvgpr_read_b32 v248, a64
    v_accvgpr_read_b32 v249, a65
    v_accvgpr_read_b32 v250, a66
    v_accvgpr_read_b32 v251, a67
    v_cvt_pk_bf16_f32 v22, v248, v249
    v_cvt_pk_bf16_f32 v23, v250, v251
    buffer_store_dwordx4 v[20:23], v10, s[96:99], s78 offen offset:3072 sc1
    v_accvgpr_read_b32 v248, a56
    v_accvgpr_read_b32 v249, a57
    v_accvgpr_read_b32 v250, a58
    v_accvgpr_read_b32 v251, a59
    v_cvt_pk_bf16_f32 v24, v248, v249
    v_cvt_pk_bf16_f32 v25, v250, v251
    v_accvgpr_read_b32 v248, a68
    v_accvgpr_read_b32 v249, a69
    v_accvgpr_read_b32 v250, a70
    v_accvgpr_read_b32 v251, a71
    v_cvt_pk_bf16_f32 v26, v248, v249
    v_cvt_pk_bf16_f32 v27, v250, v251
    s_add_u32 s78, s67, 8192
    buffer_store_dwordx4 v[24:27], v10, s[96:99], s78 offen sc1
    v_accvgpr_read_b32 v248, a72
    v_accvgpr_read_b32 v249, a73
    v_accvgpr_read_b32 v250, a74
    v_accvgpr_read_b32 v251, a75
    v_cvt_pk_bf16_f32 v28, v248, v249
    v_cvt_pk_bf16_f32 v29, v250, v251
    v_accvgpr_read_b32 v248, a84
    v_accvgpr_read_b32 v249, a85
    v_accvgpr_read_b32 v250, a86
    v_accvgpr_read_b32 v251, a87
    v_cvt_pk_bf16_f32 v30, v248, v249
    v_cvt_pk_bf16_f32 v31, v250, v251
    buffer_store_dwordx4 v[28:31], v10, s[96:99], s78 offen offset:1024 sc1
    v_accvgpr_read_b32 v248, a76
    v_accvgpr_read_b32 v249, a77
    v_accvgpr_read_b32 v250, a78
    v_accvgpr_read_b32 v251, a79
    v_cvt_pk_bf16_f32 v32, v248, v249
    v_cvt_pk_bf16_f32 v33, v250, v251
    v_accvgpr_read_b32 v248, a88
    v_accvgpr_read_b32 v249, a89
    v_accvgpr_read_b32 v250, a90
    v_accvgpr_read_b32 v251, a91
    v_cvt_pk_bf16_f32 v34, v248, v249
    v_cvt_pk_bf16_f32 v35, v250, v251
    buffer_store_dwordx4 v[32:35], v10, s[96:99], s78 offen offset:2048 sc1
    v_accvgpr_read_b32 v248, a80
    v_accvgpr_read_b32 v249, a81
    v_accvgpr_read_b32 v250, a82
    v_accvgpr_read_b32 v251, a83
    v_cvt_pk_bf16_f32 v36, v248, v249
    v_cvt_pk_bf16_f32 v37, v250, v251
    v_accvgpr_read_b32 v248, a92
    v_accvgpr_read_b32 v249, a93
    v_accvgpr_read_b32 v250, a94
    v_accvgpr_read_b32 v251, a95
    v_cvt_pk_bf16_f32 v38, v248, v249
    v_cvt_pk_bf16_f32 v39, v250, v251
    buffer_store_dwordx4 v[36:39], v10, s[96:99], s78 offen offset:3072 sc1
    s_nop 1
    s_setpc_b64 s[60:61]
L_ofinB:
    s_nop 7
    s_mul_i32 s31, s3, 384
    v_add_u32 v14, s31, v13
    v_mov_b32 v16, v88
    v_mov_b32 v17, v112
    ds_write_b64 v14, v[16:17]
    v_mov_b32 v18, v92
    v_mov_b32 v19, v116
    ds_write_b64 v14, v[18:19] offset:128
    v_mov_b32 v20, v96
    v_mov_b32 v21, v120
    ds_write_b64 v14, v[20:21] offset:256
    s_xor_b32 s78, s3, 1
    s_mul_i32 s31, s78, 384
    v_add_u32 v249, s31, v13
    s_mul_i32 s31, s78, 35328
    s_add_u32 s31, s31, 16896
    v_add_u32 v248, s31, v10
    s_add_u32 s31, s30, 16896
    v_add_u32 v15, s31, v10
    s_waitcnt lgkmcnt(0)
    s_barrier
    ds_read_b64 v[24:25], v249
    ds_read_b64 v[26:27], v249 offset:128
    ds_read_b64 v[28:29], v249 offset:256
    s_waitcnt lgkmcnt(0)
    ds_write_b128 v248, a[16:19]
    ds_write_b128 v248, a[20:23] offset:1024
    ds_write_b128 v248, a[24:27] offset:2048
    ds_write_b128 v248, a[28:31] offset:3072
    ds_write_b128 v248, a[48:51] offset:4096
    ds_write_b128 v248, a[52:55] offset:5120
    ds_write_b128 v248, a[56:59] offset:6144
    ds_write_b128 v248, a[60:63] offset:7168
    ds_write_b128 v248, a[80:83] offset:8192
    ds_write_b128 v248, a[84:87] offset:9216
    ds_write_b128 v248, a[88:91] offset:10240
    ds_write_b128 v248, a[92:95] offset:11264
    v_min_f32 v250, v24, v16
    v_sub_f32 v16, v250, v16
    v_sub_f32 v24, v250, v24
    v_exp_f32 v16, v16
    v_exp_f32 v24, v24
    v_mul_f32 v251, v16, v17
    v_fma_f32 v251, v24, v25, v251
    v_rcp_f32 v251, v251
    s_nop 0
    v_mul_f32 v236, v16, v251
    v_mul_f32 v212, v24, v251
    v_accvgpr_read_b32 v140, a0
    v_accvgpr_read_b32 v141, a1
    v_accvgpr_read_b32 v142, a2
    v_accvgpr_read_b32 v143, a3
    v_accvgpr_read_b32 v144, a4
    v_accvgpr_read_b32 v145, a5
    v_accvgpr_read_b32 v146, a6
    v_accvgpr_read_b32 v147, a7
    v_accvgpr_read_b32 v148, a8
    v_accvgpr_read_b32 v149, a9
    v_accvgpr_read_b32 v150, a10
    v_accvgpr_read_b32 v151, a11
    v_accvgpr_read_b32 v152, a12
    v_accvgpr_read_b32 v153, a13
    v_accvgpr_read_b32 v154, a14
    v_accvgpr_read_b32 v155, a15
    v_mul_f32 v140, v140, v236
    v_mul_f32 v141, v141, v236
    v_mul_f32 v142, v142, v236
    v_mul_f32 v143, v143, v236
    v_mul_f32 v144, v144, v236
    v_mul_f32 v145, v145, v236
    v_mul_f32 v146, v146, v236
    v_mul_f32 v147, v147, v236
    v_mul_f32 v148, v148, v236
    v_mul_f32 v149, v149, v236
    v_mul_f32 v150, v150, v236
    v_mul_f32 v151, v151, v236
    v_mul_f32 v152, v152, v236
    v_mul_f32 v153, v153, v236
    v_mul_f32 v154, v154, v236
    v_mul_f32 v155, v155, v236
    v_min_f32 v250, v26, v18
    v_sub_f32 v18, v250, v18
    v_sub_f32 v26, v250, v26
    v_exp_f32 v18, v18
    v_exp_f32 v26, v26
    v_mul_f32 v251, v18, v19
    v_fma_f32 v251, v26, v27, v251
    v_rcp_f32 v251, v251
    s_nop 0
    v_mul_f32 v237, v18, v251
    v_mul_f32 v213, v26, v251
    v_accvgpr_read_b32 v156, a32
    v_accvgpr_read_b32 v157, a33
    v_accvgpr_read_b32 v158, a34
    v_accvgpr_read_b32 v159, a35
    v_accvgpr_read_b32 v160, a36
    v_accvgpr_read_b32 v161, a37
    v_accvgpr_read_b32 v162, a38
    v_accvgpr_read_b32 v163, a39
    v_accvgpr_read_b32 v164, a40
    v_accvgpr_read_b32 v165, a41
    v_accvgpr_read_b32 v166, a42
    v_accvgpr_read_b32 v167, a43
    v_accvgpr_read_b32 v168, a44
    v_accvgpr_read_b32 v169, a45
    v_accvgpr_read_b32 v170, a46
    v_accvgpr_read_b32 v171, a47
    v_mul_f32 v156, v156, v237
    v_mul_f32 v157, v157, v237
    v_mul_f32 v158, v158, v237
    v_mul_f32 v159, v159, v237
    v_mul_f32 v160, v160, v237
    v_mul_f32 v161, v161, v237
    v_mul_f32 v162, v162, v237
    v_mul_f32 v163, v163, v237
    v_mul_f32 v164, v164, v237
    v_mul_f32 v165, v165, v237
    v_mul_f32 v166, v166, v237
    v_mul_f32 v167, v167, v237
    v_mul_f32 v168, v168, v237
    v_mul_f32 v169, v169, v237
    v_mul_f32 v170, v170, v237
    v_mul_f32 v171, v171, v237
    v_min_f32 v250, v28, v20
    v_sub_f32 v20, v250, v20
    v_sub_f32 v28, v250, v28
    v_exp_f32 v20, v20
    v_exp_f32 v28, v28
    v_mul_f32 v251, v20, v21
    v_fma_f32 v251, v28, v29, v251
    v_rcp_f32 v251, v251
    s_nop 0
    v_mul_f32 v238, v20, v251
    v_mul_f32 v214, v28, v251
    v_accvgpr_read_b32 v172, a64
    v_accvgpr_read_b32 v173, a65
    v_accvgpr_read_b32 v174, a66
    v_accvgpr_read_b32 v175, a67
    v_accvgpr_read_b32 v176, a68
    v_accvgpr_read_b32 v177, a69
    v_accvgpr_read_b32 v178, a70
    v_accvgpr_read_b32 v179, a71
    v_accvgpr_read_b32 v180, a72
    v_accvgpr_read_b32 v181, a73
    v_accvgpr_read_b32 v182, a74
    v_accvgpr_read_b32 v183, a75
    v_accvgpr_read_b32 v184, a76
    v_accvgpr_read_b32 v185, a77
    v_accvgpr_read_b32 v186, a78
    v_accvgpr_read_b32 v187, a79
    v_mul_f32 v172, v172, v238
    v_mul_f32 v173, v173, v238
    v_mul_f32 v174, v174, v238
    v_mul_f32 v175, v175, v238
    v_mul_f32 v176, v176, v238
    v_mul_f32 v177, v177, v238
    v_mul_f32 v178, v178, v238
    v_mul_f32 v179, v179, v238
    v_mul_f32 v180, v180, v238
    v_mul_f32 v181, v181, v238
    v_mul_f32 v182, v182, v238
    v_mul_f32 v183, v183, v238
    v_mul_f32 v184, v184, v238
    v_mul_f32 v185, v185, v238
    v_mul_f32 v186, v186, v238
    v_mul_f32 v187, v187, v238
    s_waitcnt lgkmcnt(0)
    s_barrier
    ds_read_b128 v[16:19], v15
    ds_read_b128 v[20:23], v15 offset:1024
    ds_read_b128 v[24:27], v15 offset:2048
    ds_read_b128 v[28:31], v15 offset:3072
    ds_read_b128 v[32:35], v15 offset:4096
    ds_read_b128 v[36:39], v15 offset:5120
    ds_read_b128 v[40:43], v15 offset:6144
    ds_read_b128 v[44:47], v15 offset:7168
    ds_read_b128 v[48:51], v15 offset:8192
    ds_read_b128 v[52:55], v15 offset:9216
    ds_read_b128 v[56:59], v15 offset:10240
    ds_read_b128 v[60:63], v15 offset:11264
    s_waitcnt lgkmcnt(8)
    v_fma_f32 v140, v16, v212, v140
    v_fma_f32 v141, v17, v212, v141
    v_fma_f32 v142, v18, v212, v142
    v_fma_f32 v143, v19, v212, v143
    v_fma_f32 v144, v20, v212, v144
    v_fma_f32 v145, v21, v212, v145
    v_fma_f32 v146, v22, v212, v146
    v_fma_f32 v147, v23, v212, v147
    v_fma_f32 v148, v24, v212, v148
    v_fma_f32 v149, v25, v212, v149
    v_fma_f32 v150, v26, v212, v150
    v_fma_f32 v151, v27, v212, v151
    v_fma_f32 v152, v28, v212, v152
    v_fma_f32 v153, v29, v212, v153
    v_fma_f32 v154, v30, v212, v154
    v_fma_f32 v155, v31, v212, v155
    s_waitcnt lgkmcnt(4)
    v_fma_f32 v156, v32, v213, v156
    v_fma_f32 v157, v33, v213, v157
    v_fma_f32 v158, v34, v213, v158
    v_fma_f32 v159, v35, v213, v159
    v_fma_f32 v160, v36, v213, v160
    v_fma_f32 v161, v37, v213, v161
    v_fma_f32 v162, v38, v213, v162
    v_fma_f32 v163, v39, v213, v163
    v_fma_f32 v164, v40, v213, v164
    v_fma_f32 v165, v41, v213, v165
    v_fma_f32 v166, v42, v213, v166
    v_fma_f32 v167, v43, v213, v167
    v_fma_f32 v168, v44, v213, v168
    v_fma_f32 v169, v45, v213, v169
    v_fma_f32 v170, v46, v213, v170
    v_fma_f32 v171, v47, v213, v171
    s_waitcnt lgkmcnt(0)
    v_fma_f32 v172, v48, v214, v172
    v_fma_f32 v173, v49, v214, v173
    v_fma_f32 v174, v50, v214, v174
    v_fma_f32 v175, v51, v214, v175
    v_fma_f32 v176, v52, v214, v176
    v_fma_f32 v177, v53, v214, v177
    v_fma_f32 v178, v54, v214, v178
    v_fma_f32 v179, v55, v214, v179
    v_fma_f32 v180, v56, v214, v180
    v_fma_f32 v181, v57, v214, v181
    v_fma_f32 v182, v58, v214, v182
    v_fma_f32 v183, v59, v214, v183
    v_fma_f32 v184, v60, v214, v184
    v_fma_f32 v185, v61, v214, v185
    v_fma_f32 v186, v62, v214, v186
    v_fma_f32 v187, v63, v214, v187
    v_cvt_pk_bf16_f32 v64, v140, v141
    v_cvt_pk_bf16_f32 v65, v142, v143
    v_cvt_pk_bf16_f32 v66, v144, v145
    v_cvt_pk_bf16_f32 v67, v146, v147
    ds_write_b128 v15, v[64:67]
    v_cvt_pk_bf16_f32 v68, v156, v157
    v_cvt_pk_bf16_f32 v69, v158, v159
    v_cvt_pk_bf16_f32 v70, v160, v161
    v_cvt_pk_bf16_f32 v71, v162, v163
    ds_write_b128 v15, v[68:71] offset:1024
    v_cvt_pk_bf16_f32 v72, v172, v173
    v_cvt_pk_bf16_f32 v73, v174, v175
    v_cvt_pk_bf16_f32 v74, v176, v177
    v_cvt_pk_bf16_f32 v75, v178, v179
    ds_write_b128 v15, v[72:75] offset:2048
    v_cvt_pk_bf16_f32 v76, v148, v149
    v_cvt_pk_bf16_f32 v77, v150, v151
    v_cvt_pk_bf16_f32 v78, v152, v153
    v_cvt_pk_bf16_f32 v79, v154, v155
    ds_write_b128 v15, v[76:79] offset:3072
    v_cvt_pk_bf16_f32 v80, v164, v165
    v_cvt_pk_bf16_f32 v81, v166, v167
    v_cvt_pk_bf16_f32 v82, v168, v169
    v_cvt_pk_bf16_f32 v83, v170, v171
    ds_write_b128 v15, v[80:83] offset:4096
    v_cvt_pk_bf16_f32 v84, v180, v181
    v_cvt_pk_bf16_f32 v85, v182, v183
    v_cvt_pk_bf16_f32 v86, v184, v185
    v_cvt_pk_bf16_f32 v87, v186, v187
    ds_write_b128 v15, v[84:87] offset:5120
    v_add_u32 v14, 16896, v10
    v_add_u32 v15, 87552, v10
    s_waitcnt lgkmcnt(0)
    s_barrier
    ds_read_b128 v[140:143], v14
    ds_read_b128 v[144:147], v14 offset:1024
    ds_read_b128 v[148:151], v14 offset:2048
    ds_read_b128 v[152:155], v14 offset:3072
    ds_read_b128 v[156:159], v14 offset:4096
    ds_read_b128 v[160:163], v14 offset:5120
    ds_read_b128 v[164:167], v14 offset:35328
    ds_read_b128 v[168:171], v14 offset:36352
    ds_read_b128 v[172:175], v14 offset:37376
    ds_read_b128 v[176:179], v14 offset:38400
    ds_read_b128 v[180:183], v14 offset:39424
    ds_read_b128 v[184:187], v14 offset:40448
    ds_read_b128 v[88:91], v15
    ds_read_b128 v[92:95], v15 offset:1024
    ds_read_b128 v[96:99], v15 offset:2048
    ds_read_b128 v[100:103], v15 offset:3072
    ds_read_b128 v[104:107], v15 offset:4096
    ds_read_b128 v[108:111], v15 offset:5120
    ds_read_b128 v[112:115], v15 offset:35328
    ds_read_b128 v[116:119], v15 offset:36352
    ds_read_b128 v[120:123], v15 offset:37376
    ds_read_b128 v[124:127], v15 offset:38400
    ds_read_b128 v[128:131], v15 offset:39424
    ds_read_b128 v[132:135], v15 offset:40448
    s_setpc_b64 s[60:61]
L_reduce:
    s_mul_i32 s31, s48, 43691
    s_lshr_b32 s49, s31, 21
    s_mul_i32 s31, s49, 48
    s_sub_u32 s50, s48, s31
    s_call_b64 s[62:63], L_nonce
    s_lshl_b32 s31, s49, 8
    s_add_u32 s31, s31, 41943040
    v_and_b32 v250, 15, v0
    v_lshlrev_b32 v154, 11, v250
    v_lshlrev_b32 v250, 2, v250
    v_add_u32 v250, s31, v250
    global_load_dword v15, v250, s[28:29] sc1
    v_lshrrev_b32 v14, 4, v0
    v_lshl_add_u32 v154, v14, 3, v154
    s_mul_i32 s31, s49, 786432
    s_lshl_b32 s78, s50, 10
    s_add_u32 s31, s31, s78
    s_add_u32 s32, s28, s31
    s_addc_u32 s33, s29, 0
    s_mov_b32 s34, 738304
    s_mov_b32 s36, s24
    s_mov_b32 s37, s25
    s_mov_b32 s38, 1572864
    s_mov_b32 s79, 0
    s_waitcnt vmcnt(0)
    v_cmp_ne_u32 vcc, s93, v15
    s_cbranch_vccz L_rd_go
L_rd_poll:
    s_sleep 32
    global_load_dword v15, v250, s[28:29] sc1
    s_waitcnt vmcnt(0)
    v_cmp_ne_u32 vcc, s93, v15
    s_add_u32 s79, s79, 1
    s_cbranch_vccz L_rd_go
    s_cmp_lt_u32 s79, 262144
    s_cbranch_scc1 L_rd_poll
L_rd_go:
    s_mov_b32 s31, 0
    buffer_load_dwordx4 v[16:19], v10, s[32:35], s31 offen sc1
    s_add_u32 s31, s31, 49152
    buffer_load_dwordx4 v[20:23], v10, s[32:35], s31 offen sc1
    s_add_u32 s31, s31, 49152
    buffer_load_dwordx4 v[24:27], v10, s[32:35], s31 offen sc1
    s_add_u32 s31, s31, 49152
    buffer_load_dwordx4 v[28:31], v10, s[32:35], s31 offen sc1
    s_add_u32 s31, s31, 49152
    buffer_load_dwordx4 v[32:35], v10, s[32:35], s31 offen sc1
    s_add_u32 s31, s31, 49152
    buffer_load_dwordx4 v[36:39], v10, s[32:35], s31 offen sc1
    s_add_u32 s31, s31, 49152
    buffer_load_dwordx4 v[40:43], v10, s[32:35], s31 offen sc1
    s_add_u32 s31, s31, 49152
    buffer_load_dwordx4 v[44:47], v10, s[32:35], s31 offen sc1
    s_add_u32 s31, s31, 49152
    buffer_load_dwordx4 v[48:51], v10, s[32:35], s31 offen sc1
    s_add_u32 s31, s31, 49152
    buffer_load_dwordx4 v[52:55], v10, s[32:35], s31 offen sc1
    s_add_u32 s31, s31, 49152
    buffer_load_dwordx4 v[56:59], v10, s[32:35], s31 offen sc1
    s_add_u32 s31, s31, 49152
    buffer_load_dwordx4 v[60:63], v10, s[32:35], s31 offen sc1
    s_add_u32 s31, s31, 49152
    buffer_load_dwordx4 v[64:67], v10, s[32:35], s31 offen sc1
    s_add_u32 s31, s31, 49152
    buffer_load_dwordx4 v[68:71], v10, s[32:35], s31 offen sc1
    s_add_u32 s31, s31, 49152
    buffer_load_dwordx4 v[72:75], v10, s[32:35], s31 offen sc1
    s_add_u32 s31, s31, 49152
    buffer_load_dwordx4 v[76:79], v10, s[32:35], s31 offen sc1
    s_mul_i32 s78, s50, 21846
    s_lshr_b32 s78, s78, 16
    s_mul_i32 s79, s78, 3
    s_sub_u32 s79, s50, s79
    s_and_b32 s31, s49, 15
    s_mul_i32 s31, s31, 98304
    s_lshl_b32 s79, s79, 15
    s_add_u32 s31, s31, s79
    s_lshl_b32 s78, s78, 6
    s_add_u32 s31, s31, s78
    s_lshr_b32 s78, s49, 4
    s_lshl_b32 s78, s78, 10
    s_add_u32 s31, s31, s78
    s_mov_b32 s79, 0xffff0000
    s_waitcnt vmcnt(12)
    v_lshlrev_b32 v144, 16, v16
    v_and_b32 v145, s79, v16
    v_lshlrev_b32 v146, 16, v17
    v_and_b32 v147, s79, v17
    v_lshlrev_b32 v148, 16, v18
    v_and_b32 v149, s79, v18
    v_lshlrev_b32 v150, 16, v19
    v_and_b32 v151, s79, v19
    v_lshlrev_b32 v152, 16, v20
    v_and_b32 v153, s79, v20
    v_add_f32 v144, v144, v152
    v_add_f32 v145, v145, v153
    v_lshlrev_b32 v152, 16, v21
    v_and_b32 v153, s79, v21
    v_add_f32 v146, v146, v152
    v_add_f32 v147, v147, v153
    v_lshlrev_b32 v152, 16, v22
    v_and_b32 v153, s79, v22
    v_add_f32 v148, v148, v152
    v_add_f32 v149, v149, v153
    v_lshlrev_b32 v152, 16, v23
    v_and_b32 v153, s79, v23
    v_add_f32 v150, v150, v152
    v_add_f32 v151, v151, v153
    v_lshlrev_b32 v152, 16, v24
    v_and_b32 v153, s79, v24
    v_add_f32 v144, v144, v152
    v_add_f32 v145, v145, v153
    v_lshlrev_b32 v152, 16, v25
    v_and_b32 v153, s79, v25
    v_add_f32 v146, v146, v152
    v_add_f32 v147, v147, v153
    v_lshlrev_b32 v152, 16, v26
    v_and_b32 v153, s79, v26
    v_add_f32 v148, v148, v152
    v_add_f32 v149, v149, v153
    v_lshlrev_b32 v152, 16, v27
    v_and_b32 v153, s79, v27
    v_add_f32 v150, v150, v152
    v_add_f32 v151, v151, v153
    v_lshlrev_b32 v152, 16, v28
    v_and_b32 v153, s79, v28
    v_add_f32 v144, v144, v152
    v_add_f32 v145, v145, v153
    v_lshlrev_b32 v152, 16, v29
    v_and_b32 v153, s79, v29
    v_add_f32 v146, v146, v152
    v_add_f32 v147, v147, v153
    v_lshlrev_b32 v152, 16, v30
    v_and_b32 v153, s79, v30
    v_add_f32 v148, v148, v152
    v_add_f32 v149, v149, v153
    v_lshlrev_b32 v152, 16, v31
    v_and_b32 v153, s79, v31
    v_add_f32 v150, v150, v152
    v_add_f32 v151, v151, v153
    s_waitcnt vmcnt(8)
    v_lshlrev_b32 v152, 16, v32
    v_and_b32 v153, s79, v32
    v_add_f32 v144, v144, v152
    v_add_f32 v145, v145, v153
    v_lshlrev_b32 v152, 16, v33
    v_and_b32 v153, s79, v33
    v_add_f32 v146, v146, v152
    v_add_f32 v147, v147, v153
    v_lshlrev_b32 v152, 16, v34
    v_and_b32 v153, s79, v34
    v_add_f32 v148, v148, v152
    v_add_f32 v149, v149, v153
    v_lshlrev_b32 v152, 16, v35
    v_and_b32 v153, s79, v35
    v_add_f32 v150, v150, v152
    v_add_f32 v151, v151, v153
    v_lshlrev_b32 v152, 16, v36
    v_and_b32 v153, s79, v36
    v_add_f32 v144, v144, v152
    v_add_f32 v145, v145, v153
    v_lshlrev_b32 v152, 16, v37
    v_and_b32 v153, s79, v37
    v_add_f32 v146, v146, v152
    v_add_f32 v147, v147, v153
    v_lshlrev_b32 v152, 16, v38
    v_and_b32 v153, s79, v38
    v_add_f32 v148, v148, v152
    v_add_f32 v149, v149, v153
    v_lshlrev_b32 v152, 16, v39
    v_and_b32 v153, s79, v39
    v_add_f32 v150, v150, v152
    v_add_f32 v151, v151, v153
    v_lshlrev_b32 v152, 16, v40
    v_and_b32 v153, s79, v40
    v_add_f32 v144, v144, v152
    v_add_f32 v145, v145, v153
    v_lshlrev_b32 v152, 16, v41
    v_and_b32 v153, s79, v41
    v_add_f32 v146, v146, v152
    v_add_f32 v147, v147, v153
    v_lshlrev_b32 v152, 16, v42
    v_and_b32 v153, s79, v42
    v_add_f32 v148, v148, v152
    v_add_f32 v149, v149, v153
    v_lshlrev_b32 v152, 16, v43
    v_and_b32 v153, s79, v43
    v_add_f32 v150, v150, v152
    v_add_f32 v151, v151, v153
    v_lshlrev_b32 v152, 16, v44
    v_and_b32 v153, s79, v44
    v_add_f32 v144, v144, v152
    v_add_f32 v145, v145, v153
    v_lshlrev_b32 v152, 16, v45
    v_and_b32 v153, s79, v45
    v_add_f32 v146, v146, v152
    v_add_f32 v147, v147, v153
    v_lshlrev_b32 v152, 16, v46
    v_and_b32 v153, s79, v46
    v_add_f32 v148, v148, v152
    v_add_f32 v149, v149, v153
    v_lshlrev_b32 v152, 16, v47
    v_and_b32 v153, s79, v47
    v_add_f32 v150, v150, v152
    v_add_f32 v151, v151, v153
    s_waitcnt vmcnt(4)
    v_lshlrev_b32 v152, 16, v48
    v_and_b32 v153, s79, v48
    v_add_f32 v144, v144, v152
    v_add_f32 v145, v145, v153
    v_lshlrev_b32 v152, 16, v49
    v_and_b32 v153, s79, v49
    v_add_f32 v146, v146, v152
    v_add_f32 v147, v147, v153
    v_lshlrev_b32 v152, 16, v50
    v_and_b32 v153, s79, v50
    v_add_f32 v148, v148, v152
    v_add_f32 v149, v149, v153
    v_lshlrev_b32 v152, 16, v51
    v_and_b32 v153, s79, v51
    v_add_f32 v150, v150, v152
    v_add_f32 v151, v151, v153
    v_lshlrev_b32 v152, 16, v52
    v_and_b32 v153, s79, v52
    v_add_f32 v144, v144, v152
    v_add_f32 v145, v145, v153
    v_lshlrev_b32 v152, 16, v53
    v_and_b32 v153, s79, v53
    v_add_f32 v146, v146, v152
    v_add_f32 v147, v147, v153
    v_lshlrev_b32 v152, 16, v54
    v_and_b32 v153, s79, v54
    v_add_f32 v148, v148, v152
    v_add_f32 v149, v149, v153
    v_lshlrev_b32 v152, 16, v55
    v_and_b32 v153, s79, v55
    v_add_f32 v150, v150, v152
    v_add_f32 v151, v151, v153
    v_lshlrev_b32 v152, 16, v56
    v_and_b32 v153, s79, v56
    v_add_f32 v144, v144, v152
    v_add_f32 v145, v145, v153
    v_lshlrev_b32 v152, 16, v57
    v_and_b32 v153, s79, v57
    v_add_f32 v146, v146, v152
    v_add_f32 v147, v147, v153
    v_lshlrev_b32 v152, 16, v58
    v_and_b32 v153, s79, v58
    v_add_f32 v148, v148, v152
    v_add_f32 v149, v149, v153
    v_lshlrev_b32 v152, 16, v59
    v_and_b32 v153, s79, v59
    v_add_f32 v150, v150, v152
    v_add_f32 v151, v151, v153
    v_lshlrev_b32 v152, 16, v60
    v_and_b32 v153, s79, v60
    v_add_f32 v144, v144, v152
    v_add_f32 v145, v145, v153
    v_lshlrev_b32 v152, 16, v61
    v_and_b32 v153, s79, v61
    v_add_f32 v146, v146, v152
    v_add_f32 v147, v147, v153
    v_lshlrev_b32 v152, 16, v62
    v_and_b32 v153, s79, v62
    v_add_f32 v148, v148, v152
    v_add_f32 v149, v149, v153
    v_lshlrev_b32 v152, 16, v63
    v_and_b32 v153, s79, v63
    v_add_f32 v150, v150, v152
    v_add_f32 v151, v151, v153
    s_waitcnt vmcnt(0)
    v_lshlrev_b32 v152, 16, v64
    v_and_b32 v153, s79, v64
    v_add_f32 v144, v144, v152
    v_add_f32 v145, v145, v153
    v_lshlrev_b32 v152, 16, v65
    v_and_b32 v153, s79, v65
    v_add_f32 v146, v146, v152
    v_add_f32 v147, v147, v153
    v_lshlrev_b32 v152, 16, v66
    v_and_b32 v153, s79, v66
    v_add_f32 v148, v148, v152
    v_add_f32 v149, v149, v153
    v_lshlrev_b32 v152, 16, v67
    v_and_b32 v153, s79, v67
    v_add_f32 v150, v150, v152
    v_add_f32 v151, v151, v153
    v_lshlrev_b32 v152, 16, v68
    v_and_b32 v153, s79, v68
    v_add_f32 v144, v144, v152
    v_add_f32 v145, v145, v153
    v_lshlrev_b32 v152, 16, v69
    v_and_b32 v153, s79, v69
    v_add_f32 v146, v146, v152
    v_add_f32 v147, v147, v153
    v_lshlrev_b32 v152, 16, v70
    v_and_b32 v153, s79, v70
    v_add_f32 v148, v148, v152
    v_add_f32 v149, v149, v153
    v_lshlrev_b32 v152, 16, v71
    v_and_b32 v153, s79, v71
    v_add_f32 v150, v150, v152
    v_add_f32 v151, v151, v153
    v_lshlrev_b32 v152, 16, v72
    v_and_b32 v153, s79, v72
    v_add_f32 v144, v144, v152
    v_add_f32 v145, v145, v153
    v_lshlrev_b32 v152, 16, v73
    v_and_b32 v153, s79, v73
    v_add_f32 v146, v146, v152
    v_add_f32 v147, v147, v153
    v_lshlrev_b32 v152, 16, v74
    v_and_b32 v153, s79, v74
    v_add_f32 v148, v148, v152
    v_add_f32 v149, v149, v153
    v_lshlrev_b32 v152, 16, v75
    v_and_b32 v153, s79, v75
    v_add_f32 v150, v150, v152
    v_add_f32 v151, v151, v153
    v_lshlrev_b32 v152, 16, v76
    v_and_b32 v153, s79, v76
    v_add_f32 v144, v144, v152
    v_add_f32 v145, v145, v153
    v_lshlrev_b32 v152, 16, v77
    v_and_b32 v153, s79, v77
    v_add_f32 v146, v146, v152
    v_add_f32 v147, v147, v153
    v_lshlrev_b32 v152, 16, v78
    v_and_b32 v153, s79, v78
    v_add_f32 v148, v148, v152
    v_add_f32 v149, v149, v153
    v_lshlrev_b32 v152, 16, v79
    v_and_b32 v153, s79, v79
    v_add_f32 v150, v150, v152
    v_add_f32 v151, v151, v153
    v_cvt_pk_bf16_f32 v144, v144, v145
    v_cvt_pk_bf16_f32 v145, v146, v147
    buffer_store_dwordx2 v[144:145], v154, s[36:39], s31 offen
    v_cvt_pk_bf16_f32 v148, v148, v149
    v_cvt_pk_bf16_f32 v149, v150, v151
    buffer_store_dwordx2 v[148:149], v154, s[36:39], s31 offen offset:32
    s_nop 1
    s_setpc_b64 s[60:61]
L_nonce:
    s_cmp_lg_u32 s93, 0
    s_cbranch_scc1 L_nonce_ok
    v_readfirstlane_b32 s93, v239
    s_nop 1
    s_cmp_lg_u32 s93, 0
    s_cbranch_scc1 L_nonce_ok
    v_mov_b32 v14, 0
    s_mov_b32 s79, 0
L_nonce_poll:
    global_load_dword v15, v14, s[26:27] sc1
    s_waitcnt vmcnt(0)
    v_readfirstlane_b32 s93, v15
    s_add_u32 s79, s79, 1
    s_cmp_lg_u32 s93, 0
    s_cbranch_scc1 L_nonce_ok
    s_sleep 16
    s_cmp_lt_u32 s79, 262144
    s_cbranch_scc1 L_nonce_poll
L_nonce_ok:
    s_nop 1
    s_setpc_b64 s[62:63]
L_qpack96:
    s_nop 7
    v_accvgpr_read_b32 v188, a96
    v_accvgpr_read_b32 v189, a97
    v_accvgpr_read_b32 v190, a98
    v_accvgpr_read_b32 v191, a99
    v_accvgpr_read_b32 v192, a100
    v_accvgpr_read_b32 v193, a101
    v_accvgpr_read_b32 v194, a102
    v_accvgpr_read_b32 v195, a103
    v_accvgpr_read_b32 v196, a104
    v_accvgpr_read_b32 v197, a105
    v_accvgpr_read_b32 v198, a106
    v_accvgpr_read_b32 v199, a107
    v_accvgpr_read_b32 v200, a108
    v_accvgpr_read_b32 v201, a109
    v_accvgpr_read_b32 v202, a110
    v_accvgpr_read_b32 v203, a111
    v_accvgpr_read_b32 v204, a112
    v_accvgpr_read_b32 v205, a113
    v_accvgpr_read_b32 v206, a114
    v_accvgpr_read_b32 v207, a115
    v_accvgpr_read_b32 v208, a116
    v_accvgpr_read_b32 v209, a117
    v_accvgpr_read_b32 v210, a118
    v_accvgpr_read_b32 v211, a119
    s_branch L_qpack_c
L_qpack0:
    s_nop 7
    v_accvgpr_read_b32 v188, a0
    v_accvgpr_read_b32 v189, a1
    v_accvgpr_read_b32 v190, a2
    v_accvgpr_read_b32 v191, a3
    v_accvgpr_read_b32 v192, a4
    v_accvgpr_read_b32 v193, a5
    v_accvgpr_read_b32 v194, a6
    v_accvgpr_read_b32 v195, a7
    v_accvgpr_read_b32 v196, a8
    v_accvgpr_read_b32 v197, a9
    v_accvgpr_read_b32 v198, a10
    v_accvgpr_read_b32 v199, a11
    v_accvgpr_read_b32 v200, a12
    v_accvgpr_read_b32 v201, a13
    v_accvgpr_read_b32 v202, a14
    v_accvgpr_read_b32 v203, a15
    v_accvgpr_read_b32 v204, a16
    v_accvgpr_read_b32 v205, a17
    v_accvgpr_read_b32 v206, a18
    v_accvgpr_read_b32 v207, a19
    v_accvgpr_read_b32 v208, a20
    v_accvgpr_read_b32 v209, a21
    v_accvgpr_read_b32 v210, a22
    v_accvgpr_read_b32 v211, a23
L_qpack_c:
    v_mul_f32 v188, s66, v188
    v_mul_f32 v189, s66, v189
    v_mul_f32 v190, s66, v190
    v_mul_f32 v191, s66, v191
    v_mul_f32 v192, s66, v192
    v_mul_f32 v193, s66, v193
    v_mul_f32 v194, s66, v194
    v_mul_f32 v195, s66, v195
    v_mul_f32 v196, s66, v196
    v_mul_f32 v197, s66, v197
    v_mul_f32 v198, s66, v198
    v_mul_f32 v199, s66, v199
    v_mul_f32 v200, s66, v200
    v_mul_f32 v201, s66, v201
    v_mul_f32 v202, s66, v202
    v_mul_f32 v203, s66, v203
    v_mul_f32 v204, s66, v204
    v_mul_f32 v205, s66, v205
    v_mul_f32 v206, s66, v206
    v_mul_f32 v207, s66, v207
    v_mul_f32 v208, s66, v208
    v_mul_f32 v209, s66, v209
    v_mul_f32 v210, s66, v210
    v_mul_f32 v211, s66, v211
    v_cvt_pk_bf16_f32 v212, v188, v189
    v_cvt_pk_bf16_f32 v213, v190, v191
    v_cvt_pk_bf16_f32 v214, v192, v193
    v_cvt_pk_bf16_f32 v215, v194, v195
    v_cvt_pk_bf16_f32 v216, v196, v197
    v_cvt_pk_bf16_f32 v217, v198, v199
    v_cvt_pk_bf16_f32 v218, v200, v201
    v_cvt_pk_bf16_f32 v219, v202, v203
    v_cvt_pk_bf16_f32 v220, v204, v205
    v_cvt_pk_bf16_f32 v221, v206, v207
    v_cvt_pk_bf16_f32 v222, v208, v209
    v_cvt_pk_bf16_f32 v223, v210, v211
    s_nop 1
    s_setpc_b64 s[62:63]
L_qfin96:
    s_call_b64 s[62:63], L_qpack96
    s_branch L_qput
L_qfin0:
    s_call_b64 s[62:63], L_qpack0
L_qput:
    s_waitcnt lgkmcnt(0)
    s_barrier
    ds_write_b64 v11, v[212:213]
    ds_write_b64 v11, v[214:215] offset:4608
    ds_write_b64 v11, v[216:217] offset:9216
    ds_write_b64 v11, v[218:219] offset:32
    ds_write_b64 v11, v[220:221] offset:4640
    ds_write_b64 v11, v[222:223] offset:9248
    s_waitcnt lgkmcnt(0)
    s_barrier
    s_setpc_b64 s[60:61]
L_comb2:
    s_add_u32 s31, s30, 16896
    v_add_u32 v15, s31, v10
    s_waitcnt lgkmcnt(0)
    s_barrier
    ds_read_b128 v[16:19], v15
    ds_read_b128 v[20:23], v15 offset:1024
    ds_read_b128 v[24:27], v15 offset:2048
    ds_read_b128 v[28:31], v15 offset:3072
    ds_read_b128 v[32:35], v15 offset:4096
    ds_read_b128 v[36:39], v15 offset:5120
    ds_read_b128 v[40:43], v15 offset:6144
    ds_read_b128 v[44:47], v15 offset:7168
    ds_read_b128 v[48:51], v15 offset:8192
    ds_read_b128 v[52:55], v15 offset:9216
    ds_read_b128 v[56:59], v15 offset:10240
    ds_read_b128 v[60:63], v15 offset:11264
    ds_read_b128 v[64:67], v15 offset:12288
    ds_read_b128 v[68:71], v15 offset:13312
    ds_read_b128 v[72:75], v15 offset:14336
    v_mul_f32 v188, v188, v236
    v_mul_f32 v189, v189, v236
    v_mul_f32 v190, v190, v236
    v_mul_f32 v191, v191, v236
    v_mul_f32 v192, v192, v236
    v_mul_f32 v193, v193, v236
    v_mul_f32 v194, v194, v236
    v_mul_f32 v195, v195, v236
    v_mul_f32 v196, v196, v237
    v_mul_f32 v197, v197, v237
    v_mul_f32 v198, v198, v237
    v_mul_f32 v199, v199, v237
    v_mul_f32 v200, v200, v237
    v_mul_f32 v201, v201, v237
    v_mul_f32 v202, v202, v237
    v_mul_f32 v203, v203, v237
    v_mul_f32 v204, v204, v238
    v_mul_f32 v205, v205, v238
    v_mul_f32 v206, v206, v238
    v_mul_f32 v207, v207, v238
    v_mul_f32 v208, v208, v238
    v_mul_f32 v209, v209, v238
    v_mul_f32 v210, v210, v238
    v_mul_f32 v211, v211, v238
    ds_read_b128 v[76:79], v15 offset:15360
    ds_read_b128 v[80:83], v15 offset:16384
    ds_read_b128 v[84:87], v15 offset:17408
    s_waitcnt lgkmcnt(12)
    v_fma_f32 v188, v16, v212, v188
    v_fma_f32 v189, v17, v212, v189
    v_fma_f32 v190, v18, v212, v190
    v_fma_f32 v191, v19, v212, v191
    v_fma_f32 v192, v20, v212, v192
    v_fma_f32 v193, v21, v212, v193
    v_fma_f32 v194, v22, v212, v194
    v_fma_f32 v195, v23, v212, v195
    v_fma_f32 v196, v24, v213, v196
    v_fma_f32 v197, v25, v213, v197
    v_fma_f32 v198, v26, v213, v198
    v_fma_f32 v199, v27, v213, v199
    v_fma_f32 v200, v28, v213, v200
    v_fma_f32 v201, v29, v213, v201
    v_fma_f32 v202, v30, v213, v202
    v_fma_f32 v203, v31, v213, v203
    v_fma_f32 v204, v32, v214, v204
    v_fma_f32 v205, v33, v214, v205
    v_fma_f32 v206, v34, v214, v206
    v_fma_f32 v207, v35, v214, v207
    v_fma_f32 v208, v36, v214, v208
    v_fma_f32 v209, v37, v214, v209
    v_fma_f32 v210, v38, v214, v210
    v_fma_f32 v211, v39, v214, v211
    s_waitcnt lgkmcnt(6)
    v_fma_f32 v188, v40, v215, v188
    v_fma_f32 v189, v41, v215, v189
    v_fma_f32 v190, v42, v215, v190
    v_fma_f32 v191, v43, v215, v191
    v_fma_f32 v192, v44, v215, v192
    v_fma_f32 v193, v45, v215, v193
    v_fma_f32 v194, v46, v215, v194
    v_fma_f32 v195, v47, v215, v195
    v_fma_f32 v196, v48, v216, v196
    v_fma_f32 v197, v49, v216, v197
    v_fma_f32 v198, v50, v216, v198
    v_fma_f32 v199, v51, v216, v199
    v_fma_f32 v200, v52, v216, v200
    v_fma_f32 v201, v53, v216, v201
    v_fma_f32 v202, v54, v216, v202
    v_fma_f32 v203, v55, v216, v203
    v_fma_f32 v204, v56, v217, v204
    v_fma_f32 v205, v57, v217, v205
    v_fma_f32 v206, v58, v217, v206
    v_fma_f32 v207, v59, v217, v207
    v_fma_f32 v208, v60, v217, v208
    v_fma_f32 v209, v61, v217, v209
    v_fma_f32 v210, v62, v217, v210
    v_fma_f32 v211, v63, v217, v211
    s_waitcnt lgkmcnt(0)
    v_fma_f32 v188, v64, v218, v188
    v_fma_f32 v189, v65, v218, v189
    v_fma_f32 v190, v66, v218, v190
    v_fma_f32 v191, v67, v218, v191
    v_fma_f32 v192, v68, v218, v192
    v_fma_f32 v193, v69, v218, v193
    v_fma_f32 v194, v70, v218, v194
    v_fma_f32 v195, v71, v218, v195
    v_fma_f32 v196, v72, v219, v196
    v_fma_f32 v197, v73, v219, v197
    v_fma_f32 v198, v74, v219, v198
    v_fma_f32 v199, v75, v219, v199
    v_fma_f32 v200, v76, v219, v200
    v_fma_f32 v201, v77, v219, v201
    v_fma_f32 v202, v78, v219, v202
    v_fma_f32 v203, v79, v219, v203
    v_fma_f32 v204, v80, v220, v204
    v_fma_f32 v205, v81, v220, v205
    v_fma_f32 v206, v82, v220, v206
    v_fma_f32 v207, v83, v220, v207
    v_fma_f32 v208, v84, v220, v208
    v_fma_f32 v209, v85, v220, v209
    v_fma_f32 v210, v86, v220, v210
    v_fma_f32 v211, v87, v220, v211
    s_setpc_b64 s[62:63]
L_ofin96:
    s_nop 7
    s_mul_i32 s31, s3, 384
    v_add_u32 v14, s31, v13
    v_mov_b32 v16, v100
    v_mov_b32 v17, v124
    ds_write_b64 v14, v[16:17]
    v_mov_b32 v18, v104
    v_mov_b32 v19, v128
    ds_write_b64 v14, v[18:19] offset:128
    v_mov_b32 v20, v108
    v_mov_b32 v21, v132
    ds_write_b64 v14, v[20:21] offset:256
    s_xor_b32 s31, s3, 1
    s_mul_i32 s31, s31, 384
    v_add_u32 v44, s31, v13
    s_xor_b32 s31, s3, 2
    s_mul_i32 s31, s31, 384
    v_add_u32 v45, s31, v13
    s_xor_b32 s31, s3, 3
    s_mul_i32 s31, s31, 384
    v_add_u32 v46, s31, v13
    s_xor_b32 s31, s3, 1
    s_mul_i32 s31, s31, 35328
    s_add_u32 s31, s31, 16896
    v_add_u32 v248, s31, v10
    s_xor_b32 s31, s3, 2
    s_mul_i32 s31, s31, 35328
    s_add_u32 s31, s31, 23040
    v_add_u32 v249, s31, v10
    s_xor_b32 s31, s3, 3
    s_mul_i32 s31, s31, 35328
    s_add_u32 s31, s31, 29184
    v_add_u32 v250, s31, v10
    s_waitcnt lgkmcnt(0)
    s_barrier
    ds_read_b64 v[24:25], v44
    ds_read_b64 v[26:27], v44 offset:128
    ds_read_b64 v[28:29], v44 offset:256
    ds_read_b64 v[30:31], v45
    ds_read_b64 v[32:33], v45 offset:128
    ds_read_b64 v[34:35], v45 offset:256
    ds_read_b64 v[36:37], v46
    ds_read_b64 v[38:39], v46 offset:128
    ds_read_b64 v[40:41], v46 offset:256
    s_waitcnt lgkmcnt(0)
    ds_write_b128 v248, a[104:107]
    ds_write_b128 v248, a[108:111] offset:1024
    ds_write_b128 v248, a[136:139] offset:2048
    ds_write_b128 v248, a[140:143] offset:3072
    ds_write_b128 v248, a[168:171] offset:4096
    ds_write_b128 v248, a[172:175] offset:5120
    ds_write_b128 v249, a[112:115]
    ds_write_b128 v249, a[116:119] offset:1024
    ds_write_b128 v249, a[144:147] offset:2048
    ds_write_b128 v249, a[148:151] offset:3072
    ds_write_b128 v249, a[176:179] offset:4096
    ds_write_b128 v249, a[180:183] offset:5120
    ds_write_b128 v250, a[120:123]
    ds_write_b128 v250, a[124:127] offset:1024
    ds_write_b128 v250, a[152:155] offset:2048
    ds_write_b128 v250, a[156:159] offset:3072
    ds_write_b128 v250, a[184:187] offset:4096
    ds_write_b128 v250, a[188:191] offset:5120
    v_accvgpr_read_b32 v188, a96
    v_accvgpr_read_b32 v189, a97
    v_accvgpr_read_b32 v190, a98
    v_accvgpr_read_b32 v191, a99
    v_accvgpr_read_b32 v192, a100
    v_accvgpr_read_b32 v193, a101
    v_accvgpr_read_b32 v194, a102
    v_accvgpr_read_b32 v195, a103
    v_accvgpr_read_b32 v196, a128
    v_accvgpr_read_b32 v197, a129
    v_accvgpr_read_b32 v198, a130
    v_accvgpr_read_b32 v199, a131
    v_accvgpr_read_b32 v200, a132
    v_accvgpr_read_b32 v201, a133
    v_accvgpr_read_b32 v202, a134
    v_accvgpr_read_b32 v203, a135
    v_accvgpr_read_b32 v204, a160
    v_accvgpr_read_b32 v205, a161
    v_accvgpr_read_b32 v206, a162
    v_accvgpr_read_b32 v207, a163
    v_accvgpr_read_b32 v208, a164
    v_accvgpr_read_b32 v209, a165
    v_accvgpr_read_b32 v210, a166
    v_accvgpr_read_b32 v211, a167
    s_branch L_ofin_c
L_ofin0:
    s_nop 7
    s_mul_i32 s31, s3, 384
    v_add_u32 v14, s31, v13
    v_mov_b32 v16, v88
    v_mov_b32 v17, v112
    ds_write_b64 v14, v[16:17]
    v_mov_b32 v18, v92
    v_mov_b32 v19, v116
    ds_write_b64 v14, v[18:19] offset:128
    v_mov_b32 v20, v96
    v_mov_b32 v21, v120
    ds_write_b64 v14, v[20:21] offset:256
    s_xor_b32 s31, s3, 1
    s_mul_i32 s31, s31, 384
    v_add_u32 v44, s31, v13
    s_xor_b32 s31, s3, 2
    s_mul_i32 s31, s31, 384
    v_add_u32 v45, s31, v13
    s_xor_b32 s31, s3, 3
    s_mul_i32 s31, s31, 384
    v_add_u32 v46, s31, v13
    s_xor_b32 s31, s3, 1
    s_mul_i32 s31, s31, 35328
    s_add_u32 s31, s31, 16896
    v_add_u32 v248, s31, v10
    s_xor_b32 s31, s3, 2
    s_mul_i32 s31, s31, 35328
    s_add_u32 s31, s31, 23040
    v_add_u32 v249, s31, v10
    s_xor_b32 s31, s3, 3
    s_mul_i32 s31, s31, 35328
    s_add_u32 s31, s31, 29184
    v_add_u32 v250, s31, v10
    s_waitcnt lgkmcnt(0)
    s_barrier
    ds_read_b64 v[24:25], v44
    ds_read_b64 v[26:27], v44 offset:128
    ds_read_b64 v[28:29], v44 offset:256
    ds_read_b64 v[30:31], v45
    ds_read_b64 v[32:33], v45 offset:128
    ds_read_b64 v[34:35], v45 offset:256
    ds_read_b64 v[36:37], v46
    ds_read_b64 v[38:39], v46 offset:128
    ds_read_b64 v[40:41], v46 offset:256
    s_waitcnt lgkmcnt(0)
    ds_write_b128 v248, a[8:11]
    ds_write_b128 v248, a[12:15] offset:1024
    ds_write_b128 v248, a[40:43] offset:2048
    ds_write_b128 v248, a[44:47] offset:3072
    ds_write_b128 v248, a[72:75] offset:4096
    ds_write_b128 v248, a[76:79] offset:5120
    ds_write_b128 v249, a[16:19]
    ds_write_b128 v249, a[20:23] offset:1024
    ds_write_b128 v249, a[48:51] offset:2048
    ds_write_b128 v249, a[52:55] offset:3072
    ds_write_b128 v249, a[80:83] offset:4096
    ds_write_b128 v249, a[84:87] offset:5120
    ds_write_b128 v250, a[24:27]
    ds_write_b128 v250, a[28:31] offset:1024
    ds_write_b128 v250, a[56:59] offset:2048
    ds_write_b128 v250, a[60:63] offset:3072
    ds_write_b128 v250, a[88:91] offset:4096
    ds_write_b128 v250, a[92:95] offset:5120
    v_accvgpr_read_b32 v188, a0
    v_accvgpr_read_b32 v189, a1
    v_accvgpr_read_b32 v190, a2
    v_accvgpr_read_b32 v191, a3
    v_accvgpr_read_b32 v192, a4
    v_accvgpr_read_b32 v193, a5
    v_accvgpr_read_b32 v194, a6
    v_accvgpr_read_b32 v195, a7
    v_accvgpr_read_b32 v196, a32
    v_accvgpr_read_b32 v197, a33
    v_accvgpr_read_b32 v198, a34
    v_accvgpr_read_b32 v199, a35
    v_accvgpr_read_b32 v200, a36
    v_accvgpr_read_b32 v201, a37
    v_accvgpr_read_b32 v202, a38
    v_accvgpr_read_b32 v203, a39
    v_accvgpr_read_b32 v204, a64
    v_accvgpr_read_b32 v205, a65
    v_accvgpr_read_b32 v206, a66
    v_accvgpr_read_b32 v207, a67
    v_accvgpr_read_b32 v208, a68
    v_accvgpr_read_b32 v209, a69
    v_accvgpr_read_b32 v210, a70
    v_accvgpr_read_b32 v211, a71
L_ofin_c:
    v_min3_f32 v47, v24, v30, v36
    v_min_f32 v47, v47, v16
    v_sub_f32 v16, v47, v16
    v_sub_f32 v24, v47, v24
    v_sub_f32 v30, v47, v30
    v_sub_f32 v36, v47, v36
    v_exp_f32 v16, v16
    v_exp_f32 v24, v24
    v_exp_f32 v30, v30
    v_exp_f32 v36, v36
    v_mul_f32 v48, v16, v17
    v_fma_f32 v48, v24, v25, v48
    v_fma_f32 v48, v30, v31, v48
    v_fma_f32 v48, v36, v37, v48
    v_rcp_f32 v48, v48
    s_nop 0
    v_mul_f32 v236, v16, v48
    v_mul_f32 v212, v24, v48
    v_mul_f32 v215, v30, v48
    v_mul_f32 v218, v36, v48
    v_min3_f32 v47, v26, v32, v38
    v_min_f32 v47, v47, v18
    v_sub_f32 v18, v47, v18
    v_sub_f32 v26, v47, v26
    v_sub_f32 v32, v47, v32
    v_sub_f32 v38, v47, v38
    v_exp_f32 v18, v18
    v_exp_f32 v26, v26
    v_exp_f32 v32, v32
    v_exp_f32 v38, v38
    v_mul_f32 v48, v18, v19
    v_fma_f32 v48, v26, v27, v48
    v_fma_f32 v48, v32, v33, v48
    v_fma_f32 v48, v38, v39, v48
    v_rcp_f32 v48, v48
    s_nop 0
    v_mul_f32 v237, v18, v48
    v_mul_f32 v213, v26, v48
    v_mul_f32 v216, v32, v48
    v_mul_f32 v219, v38, v48
    v_min3_f32 v47, v28, v34, v40
    v_min_f32 v47, v47, v20
    v_sub_f32 v20, v47, v20
    v_sub_f32 v28, v47, v28
    v_sub_f32 v34, v47, v34
    v_sub_f32 v40, v47, v40
    v_exp_f32 v20, v20
    v_exp_f32 v28, v28
    v_exp_f32 v34, v34
    v_exp_f32 v40, v40
    v_mul_f32 v48, v20, v21
    v_fma_f32 v48, v28, v29, v48
    v_fma_f32 v48, v34, v35, v48
    v_fma_f32 v48, v40, v41, v48
    v_rcp_f32 v48, v48
    s_nop 0
    v_mul_f32 v238, v20, v48
    v_mul_f32 v214, v28, v48
    v_mul_f32 v217, v34, v48
    v_mul_f32 v220, v40, v48
    s_call_b64 s[62:63], L_comb2
    s_mul_i32 s31, s3, 3072
    s_add_u32 s31, s31, 141312
    v_add_u32 v15, s31, v10
    v_cvt_pk_bf16_f32 v16, v188, v189
    v_cvt_pk_bf16_f32 v17, v190, v191
    v_cvt_pk_bf16_f32 v18, v192, v193
    v_cvt_pk_bf16_f32 v19, v194, v195
    ds_write_b128 v15, v[16:19]
    v_cvt_pk_bf16_f32 v20, v196, v197
    v_cvt_pk_bf16_f32 v21, v198, v199
    v_cvt_pk_bf16_f32 v22, v200, v201
    v_cvt_pk_bf16_f32 v23, v202, v203
    ds_write_b128 v15, v[20:23] offset:1024
    v_cvt_pk_bf16_f32 v24, v204, v205
    v_cvt_pk_bf16_f32 v25, v206, v207
    v_cvt_pk_bf16_f32 v26, v208, v209
    v_cvt_pk_bf16_f32 v27, v210, v211
    ds_write_b128 v15, v[24:27] offset:2048
    v_add_u32 v14, 141312, v10
    s_waitcnt lgkmcnt(0)
    s_barrier
    s_setpc_b64 s[60:61]
L_rare1_6:
    s_nop 7
    v_max3_f32 v248, v16, v17, v18
    v_max3_f32 v248, v248, v19, v20
    v_max3_f32 v248, v248, v21, v22
    v_max_f32 v248, v248, v23
    v_mov_b32 v249, v248
    s_nop 1
    v_permlane16_swap_b32 v248, v249
    v_max_f32 v248, v248, v249
    v_mov_b32 v249, v248
    s_nop 1
    v_permlane32_swap_b32 v248, v249
    v_max_f32 v248, v248, v249
    v_max_f32 v248, s65, v248
    v_sub_f32 v16, v16, v248
    v_sub_f32 v17, v17, v248
    v_sub_f32 v18, v18, v248
    v_sub_f32 v19, v19, v248
    v_sub_f32 v20, v20, v248
    v_sub_f32 v21, v21, v248
    v_sub_f32 v22, v22, v248
    v_sub_f32 v23, v23, v248
    v_sub_f32 v88, v88, v248
    v_sub_f32 v89, v89, v248
    v_sub_f32 v90, v90, v248
    v_sub_f32 v91, v91, v248
    v_sub_f32 v249, 0, v248
    v_exp_f32 v240, v249
    v_max3_f32 v248, v24, v25, v26
    v_max3_f32 v248, v248, v27, v28
    v_max3_f32 v248, v248, v29, v30
    v_max_f32 v248, v248, v31
    v_mov_b32 v249, v248
    s_nop 1
    v_permlane16_swap_b32 v248, v249
    v_max_f32 v248, v248, v249
    v_mov_b32 v249, v248
    s_nop 1
    v_permlane32_swap_b32 v248, v249
    v_max_f32 v248, v248, v249
    v_max_f32 v248, s65, v248
    v_sub_f32 v24, v24, v248
    v_sub_f32 v25, v25, v248
    v_sub_f32 v26, v26, v248
    v_sub_f32 v27, v27, v248
    v_sub_f32 v28, v28, v248
    v_sub_f32 v29, v29, v248
    v_sub_f32 v30, v30, v248
    v_sub_f32 v31, v31, v248
    v_sub_f32 v92, v92, v248
    v_sub_f32 v93, v93, v248
    v_sub_f32 v94, v94, v248
    v_sub_f32 v95, v95, v248
    v_sub_f32 v249, 0, v248
    v_exp_f32 v241, v249
    v_max3_f32 v248, v32, v33, v34
    v_max3_f32 v248, v248, v35, v36
    v_max3_f32 v248, v248, v37, v38
    v_max_f32 v248, v248, v39
    v_mov_b32 v249, v248
    s_nop 1
    v_permlane16_swap_b32 v248, v249
    v_max_f32 v248, v248, v249
    v_mov_b32 v249, v248
    s_nop 1
    v_permlane32_swap_b32 v248, v249
    v_max_f32 v248, v248, v249
    v_max_f32 v248, s65, v248
    v_sub_f32 v32, v32, v248
    v_sub_f32 v33, v33, v248
    v_sub_f32 v34, v34, v248
    v_sub_f32 v35, v35, v248
    v_sub_f32 v36, v36, v248
    v_sub_f32 v37, v37, v248
    v_sub_f32 v38, v38, v248
    v_sub_f32 v39, v39, v248
    v_sub_f32 v96, v96, v248
    v_sub_f32 v97, v97, v248
    v_sub_f32 v98, v98, v248
    v_sub_f32 v99, v99, v248
    v_sub_f32 v249, 0, v248
    v_exp_f32 v242, v249
    v_max3_f32 v248, v40, v41, v42
    v_max3_f32 v248, v248, v43, v44
    v_max3_f32 v248, v248, v45, v46
    v_max_f32 v248, v248, v47
    v_mov_b32 v249, v248
    s_nop 1
    v_permlane16_swap_b32 v248, v249
    v_max_f32 v248, v248, v249
    v_mov_b32 v249, v248
    s_nop 1
    v_permlane32_swap_b32 v248, v249
    v_max_f32 v248, v248, v249
    v_max_f32 v248, s65, v248
    v_sub_f32 v40, v40, v248
    v_sub_f32 v41, v41, v248
    v_sub_f32 v42, v42, v248
    v_sub_f32 v43, v43, v248
    v_sub_f32 v44, v44, v248
    v_sub_f32 v45, v45, v248
    v_sub_f32 v46, v46, v248
    v_sub_f32 v47, v47, v248
    v_sub_f32 v100, v100, v248
    v_sub_f32 v101, v101, v248
    v_sub_f32 v102, v102, v248
    v_sub_f32 v103, v103, v248
    v_sub_f32 v249, 0, v248
    v_exp_f32 v243, v249
    v_max3_f32 v248, v48, v49, v50
    v_max3_f32 v248, v248, v51, v52
    v_max3_f32 v248, v248, v53, v54
    v_max_f32 v248, v248, v55
    v_mov_b32 v249, v248
    s_nop 1
    v_permlane16_swap_b32 v248, v249
    v_max_f32 v248, v248, v249
    v_mov_b32 v249, v248
    s_nop 1
    v_permlane32_swap_b32 v248, v249
    v_max_f32 v248, v248, v249
    v_max_f32 v248, s65, v248
    v_sub_f32 v48, v48, v248
    v_sub_f32 v49, v49, v248
    v_sub_f32 v50, v50, v248
    v_sub_f32 v51, v51, v248
    v_sub_f32 v52, v52, v248
    v_sub_f32 v53, v53, v248
    v_sub_f32 v54, v54, v248
    v_sub_f32 v55, v55, v248
    v_sub_f32 v104, v104, v248
    v_sub_f32 v105, v105, v248
    v_sub_f32 v106, v106, v248
    v_sub_f32 v107, v107, v248
    v_sub_f32 v249, 0, v248
    v_exp_f32 v244, v249
    v_max3_f32 v248, v56, v57, v58
    v_max3_f32 v248, v248, v59, v60
    v_max3_f32 v248, v248, v61, v62
    v_max_f32 v248, v248, v63
    v_mov_b32 v249, v248
    s_nop 1
    v_permlane16_swap_b32 v248, v249
    v_max_f32 v248, v248, v249
    v_mov_b32 v249, v248
    s_nop 1
    v_permlane32_swap_b32 v248, v249
    v_max_f32 v248, v248, v249
    v_max_f32 v248, s65, v248
    v_sub_f32 v56, v56, v248
    v_sub_f32 v57, v57, v248
    v_sub_f32 v58, v58, v248
    v_sub_f32 v59, v59, v248
    v_sub_f32 v60, v60, v248
    v_sub_f32 v61, v61, v248
    v_sub_f32 v62, v62, v248
    v_sub_f32 v63, v63, v248
    v_sub_f32 v108, v108, v248
    v_sub_f32 v109, v109, v248
    v_sub_f32 v110, v110, v248
    v_sub_f32 v111, v111, v248
    v_sub_f32 v249, 0, v248
    v_exp_f32 v245, v249
    s_mov_b32 s59, 1
    s_nop 1
    s_setpc_b64 s[62:63]
L_rare1_3:
    s_nop 7
    v_max3_f32 v248, v16, v17, v18
    v_max3_f32 v248, v248, v19, v20
    v_max3_f32 v248, v248, v21, v22
    v_max_f32 v248, v248, v23
    v_mov_b32 v249, v248
    s_nop 1
    v_permlane16_swap_b32 v248, v249
    v_max_f32 v248, v248, v249
    v_mov_b32 v249, v248
    s_nop 1
    v_permlane32_swap_b32 v248, v249
    v_max_f32 v248, v248, v249
    v_max_f32 v248, s65, v248
    v_sub_f32 v16, v16, v248
    v_sub_f32 v17, v17, v248
    v_sub_f32 v18, v18, v248
    v_sub_f32 v19, v19, v248
    v_sub_f32 v20, v20, v248
    v_sub_f32 v21, v21, v248
    v_sub_f32 v22, v22, v248
    v_sub_f32 v23, v23, v248
    v_sub_f32 v88, v88, v248
    v_sub_f32 v89, v89, v248
    v_sub_f32 v90, v90, v248
    v_sub_f32 v91, v91, v248
    v_sub_f32 v249, 0, v248
    v_exp_f32 v240, v249
    v_max3_f32 v248, v24, v25, v26
    v_max3_f32 v248, v248, v27, v28
    v_max3_f32 v248, v248, v29, v30
    v_max_f32 v248, v248, v31
    v_mov_b32 v249, v248
    s_nop 1
    v_permlane16_swap_b32 v248, v249
    v_max_f32 v248, v248, v249
    v_mov_b32 v249, v248
    s_nop 1
    v_permlane32_swap_b32 v248, v249
    v_max_f32 v248, v248, v249
    v_max_f32 v248, s65, v248
    v_sub_f32 v24, v24, v248
    v_sub_f32 v25, v25, v248
    v_sub_f32 v26, v26, v248
    v_sub_f32 v27, v27, v248
    v_sub_f32 v28, v28, v248
    v_sub_f32 v29, v29, v248
    v_sub_f32 v30, v30, v248
    v_sub_f32 v31, v31, v248
    v_sub_f32 v92, v92, v248
    v_sub_f32 v93, v93, v248
    v_sub_f32 v94, v94, v248
    v_sub_f32 v95, v95, v248
    v_sub_f32 v249, 0, v248
    v_exp_f32 v241, v249
    v_max3_f32 v248, v32, v33, v34
    v_max3_f32 v248, v248, v35, v36
    v_max3_f32 v248, v248, v37, v38
    v_max_f32 v248, v248, v39
    v_mov_b32 v249, v248
    s_nop 1
    v_permlane16_swap_b32 v248, v249
    v_max_f32 v248, v248, v249
    v_mov_b32 v249, v248
    s_nop 1
    v_permlane32_swap_b32 v248, v249
    v_max_f32 v248, v248, v249
    v_max_f32 v248, s65, v248
    v_sub_f32 v32, v32, v248
    v_sub_f32 v33, v33, v248
    v_sub_f32 v34, v34, v248
    v_sub_f32 v35, v35, v248
    v_sub_f32 v36, v36, v248
    v_sub_f32 v37, v37, v248
    v_sub_f32 v38, v38, v248
    v_sub_f32 v39, v39, v248
    v_sub_f32 v96, v96, v248
    v_sub_f32 v97, v97, v248
    v_sub_f32 v98, v98, v248
    v_sub_f32 v99, v99, v248
    v_sub_f32 v249, 0, v248
    v_exp_f32 v242, v249
    s_mov_b32 s59, 1
    s_nop 1
    s_setpc_b64 s[62:63]
L_rare2_6:
    s_nop 7
    s_nop 7
    v_accvgpr_read_b32 v248, a0
    v_accvgpr_read_b32 v249, a1
    v_accvgpr_read_b32 v250, a2
    v_accvgpr_read_b32 v251, a3
    v_mul_f32 v248, v248, v240
    v_mul_f32 v249, v249, v240
    v_mul_f32 v250, v250, v240
    v_mul_f32 v251, v251, v240
    v_accvgpr_write_b32 a0, v248
    v_accvgpr_write_b32 a1, v249
    v_accvgpr_write_b32 a2, v250
    v_accvgpr_write_b32 a3, v251
    v_accvgpr_read_b32 v248, a4
    v_accvgpr_read_b32 v249, a5
    v_accvgpr_read_b32 v250, a6
    v_accvgpr_read_b32 v251, a7
    v_mul_f32 v248, v248, v240
    v_mul_f32 v249, v249, v240
    v_mul_f32 v250, v250, v240
    v_mul_f32 v251, v251, v240
    v_accvgpr_write_b32 a4, v248
    v_accvgpr_write_b32 a5, v249
    v_accvgpr_write_b32 a6, v250
    v_accvgpr_write_b32 a7, v251
    v_accvgpr_read_b32 v248, a8
    v_accvgpr_read_b32 v249, a9
    v_accvgpr_read_b32 v250, a10
    v_accvgpr_read_b32 v251, a11
    v_mul_f32 v248, v248, v240
    v_mul_f32 v249, v249, v240
    v_mul_f32 v250, v250, v240
    v_mul_f32 v251, v251, v240
    v_accvgpr_write_b32 a8, v248
    v_accvgpr_write_b32 a9, v249
    v_accvgpr_write_b32 a10, v250
    v_accvgpr_write_b32 a11, v251
    v_accvgpr_read_b32 v248, a12
    v_accvgpr_read_b32 v249, a13
    v_accvgpr_read_b32 v250, a14
    v_accvgpr_read_b32 v251, a15
    v_mul_f32 v248, v248, v240
    v_mul_f32 v249, v249, v240
    v_mul_f32 v250, v250, v240
    v_mul_f32 v251, v251, v240
    v_accvgpr_write_b32 a12, v248
    v_accvgpr_write_b32 a13, v249
    v_accvgpr_write_b32 a14, v250
    v_accvgpr_write_b32 a15, v251
    v_accvgpr_read_b32 v248, a16
    v_accvgpr_read_b32 v249, a17
    v_accvgpr_read_b32 v250, a18
    v_accvgpr_read_b32 v251, a19
    v_mul_f32 v248, v248, v240
    v_mul_f32 v249, v249, v240
    v_mul_f32 v250, v250, v240
    v_mul_f32 v251, v251, v240
    v_accvgpr_write_b32 a16, v248
    v_accvgpr_write_b32 a17, v249
    v_accvgpr_write_b32 a18, v250
    v_accvgpr_write_b32 a19, v251
    v_accvgpr_read_b32 v248, a20
    v_accvgpr_read_b32 v249, a21
    v_accvgpr_read_b32 v250, a22
    v_accvgpr_read_b32 v251, a23
    v_mul_f32 v248, v248, v240
    v_mul_f32 v249, v249, v240
    v_mul_f32 v250, v250, v240
    v_mul_f32 v251, v251, v240
    v_accvgpr_write_b32 a20, v248
    v_accvgpr_write_b32 a21, v249
    v_accvgpr_write_b32 a22, v250
    v_accvgpr_write_b32 a23, v251
    v_accvgpr_read_b32 v248, a24
    v_accvgpr_read_b32 v249, a25
    v_accvgpr_read_b32 v250, a26
    v_accvgpr_read_b32 v251, a27
    v_mul_f32 v248, v248, v240
    v_mul_f32 v249, v249, v240
    v_mul_f32 v250, v250, v240
    v_mul_f32 v251, v251, v240
    v_accvgpr_write_b32 a24, v248
    v_accvgpr_write_b32 a25, v249
    v_accvgpr_write_b32 a26, v250
    v_accvgpr_write_b32 a27, v251
    v_accvgpr_read_b32 v248, a28
    v_accvgpr_read_b32 v249, a29
    v_accvgpr_read_b32 v250, a30
    v_accvgpr_read_b32 v251, a31
    v_mul_f32 v248, v248, v240
    v_mul_f32 v249, v249, v240
    v_mul_f32 v250, v250, v240
    v_mul_f32 v251, v251, v240
    v_accvgpr_write_b32 a28, v248
    v_accvgpr_write_b32 a29, v249
    v_accvgpr_write_b32 a30, v250
    v_accvgpr_write_b32 a31, v251
    v_mul_f32 v112, v112, v240
    v_mul_f32 v113, v113, v240
    v_mul_f32 v114, v114, v240
    v_mul_f32 v115, v115, v240
    v_accvgpr_read_b32 v248, a32
    v_accvgpr_read_b32 v249, a33
    v_accvgpr_read_b32 v250, a34
    v_accvgpr_read_b32 v251, a35
    v_mul_f32 v248, v248, v241
    v_mul_f32 v249, v249, v241
    v_mul_f32 v250, v250, v241
    v_mul_f32 v251, v251, v241
    v_accvgpr_write_b32 a32, v248
    v_accvgpr_write_b32 a33, v249
    v_accvgpr_write_b32 a34, v250
    v_accvgpr_write_b32 a35, v251
    v_accvgpr_read_b32 v248, a36
    v_accvgpr_read_b32 v249, a37
    v_accvgpr_read_b32 v250, a38
    v_accvgpr_read_b32 v251, a39
    v_mul_f32 v248, v248, v241
    v_mul_f32 v249, v249, v241
    v_mul_f32 v250, v250, v241
    v_mul_f32 v251, v251, v241
    v_accvgpr_write_b32 a36, v248
    v_accvgpr_write_b32 a37, v249
    v_accvgpr_write_b32 a38, v250
    v_accvgpr_write_b32 a39, v251
    v_accvgpr_read_b32 v248, a40
    v_accvgpr_read_b32 v249, a41
    v_accvgpr_read_b32 v250, a42
    v_accvgpr_read_b32 v251, a43
    v_mul_f32 v248, v248, v241
    v_mul_f32 v249, v249, v241
    v_mul_f32 v250, v250, v241
    v_mul_f32 v251, v251, v241
    v_accvgpr_write_b32 a40, v248
    v_accvgpr_write_b32 a41, v249
    v_accvgpr_write_b32 a42, v250
    v_accvgpr_write_b32 a43, v251
    v_accvgpr_read_b32 v248, a44
    v_accvgpr_read_b32 v249, a45
    v_accvgpr_read_b32 v250, a46
    v_accvgpr_read_b32 v251, a47
    v_mul_f32 v248, v248, v241
    v_mul_f32 v249, v249, v241
    v_mul_f32 v250, v250, v241
    v_mul_f32 v251, v251, v241
    v_accvgpr_write_b32 a44, v248
    v_accvgpr_write_b32 a45, v249
    v_accvgpr_write_b32 a46, v250
    v_accvgpr_write_b32 a47, v251
    v_accvgpr_read_b32 v248, a48
    v_accvgpr_read_b32 v249, a49
    v_accvgpr_read_b32 v250, a50
    v_accvgpr_read_b32 v251, a51
    v_mul_f32 v248, v248, v241
    v_mul_f32 v249, v249, v241
    v_mul_f32 v250, v250, v241
    v_mul_f32 v251, v251, v241
    v_accvgpr_write_b32 a48, v248
    v_accvgpr_write_b32 a49, v249
    v_accvgpr_write_b32 a50, v250
    v_accvgpr_write_b32 a51, v251
    v_accvgpr_read_b32 v248, a52
    v_accvgpr_read_b32 v249, a53
    v_accvgpr_read_b32 v250, a54
    v_accvgpr_read_b32 v251, a55
    v_mul_f32 v248, v248, v241
    v_mul_f32 v249, v249, v241
    v_mul_f32 v250, v250, v241
    v_mul_f32 v251, v251, v241
    v_accvgpr_write_b32 a52, v248
    v_accvgpr_write_b32 a53, v249
    v_accvgpr_write_b32 a54, v250
    v_accvgpr_write_b32 a55, v251
    v_accvgpr_read_b32 v248, a56
    v_accvgpr_read_b32 v249, a57
    v_accvgpr_read_b32 v250, a58
    v_accvgpr_read_b32 v251, a59
    v_mul_f32 v248, v248, v241
    v_mul_f32 v249, v249, v241
    v_mul_f32 v250, v250, v241
    v_mul_f32 v251, v251, v241
    v_accvgpr_write_b32 a56, v248
    v_accvgpr_write_b32 a57, v249
    v_accvgpr_write_b32 a58, v250
    v_accvgpr_write_b32 a59, v251
    v_accvgpr_read_b32 v248, a60
    v_accvgpr_read_b32 v249, a61
    v_accvgpr_read_b32 v250, a62
    v_accvgpr_read_b32 v251, a63
    v_mul_f32 v248, v248, v241
    v_mul_f32 v249, v249, v241
    v_mul_f32 v250, v250, v241
    v_mul_f32 v251, v251, v241
    v_accvgpr_write_b32 a60, v248
    v_accvgpr_write_b32 a61, v249
    v_accvgpr_write_b32 a62, v250
    v_accvgpr_write_b32 a63, v251
    v_mul_f32 v116, v116, v241
    v_mul_f32 v117, v117, v241
    v_mul_f32 v118, v118, v241
    v_mul_f32 v119, v119, v241
    v_accvgpr_read_b32 v248, a64
    v_accvgpr_read_b32 v249, a65
    v_accvgpr_read_b32 v250, a66
    v_accvgpr_read_b32 v251, a67
    v_mul_f32 v248, v248, v242
    v_mul_f32 v249, v249, v242
    v_mul_f32 v250, v250, v242
    v_mul_f32 v251, v251, v242
    v_accvgpr_write_b32 a64, v248
    v_accvgpr_write_b32 a65, v249
    v_accvgpr_write_b32 a66, v250
    v_accvgpr_write_b32 a67, v251
    v_accvgpr_read_b32 v248, a68
    v_accvgpr_read_b32 v249, a69
    v_accvgpr_read_b32 v250, a70
    v_accvgpr_read_b32 v251, a71
    v_mul_f32 v248, v248, v242
    v_mul_f32 v249, v249, v242
    v_mul_f32 v250, v250, v242
    v_mul_f32 v251, v251, v242
    v_accvgpr_write_b32 a68, v248
    v_accvgpr_write_b32 a69, v249
    v_accvgpr_write_b32 a70, v250
    v_accvgpr_write_b32 a71, v251
    v_accvgpr_read_b32 v248, a72
    v_accvgpr_read_b32 v249, a73
    v_accvgpr_read_b32 v250, a74
    v_accvgpr_read_b32 v251, a75
    v_mul_f32 v248, v248, v242
    v_mul_f32 v249, v249, v242
    v_mul_f32 v250, v250, v242
    v_mul_f32 v251, v251, v242
    v_accvgpr_write_b32 a72, v248
    v_accvgpr_write_b32 a73, v249
    v_accvgpr_write_b32 a74, v250
    v_accvgpr_write_b32 a75, v251
    v_accvgpr_read_b32 v248, a76
    v_accvgpr_read_b32 v249, a77
    v_accvgpr_read_b32 v250, a78
    v_accvgpr_read_b32 v251, a79
    v_mul_f32 v248, v248, v242
    v_mul_f32 v249, v249, v242
    v_mul_f32 v250, v250, v242
    v_mul_f32 v251, v251, v242
    v_accvgpr_write_b32 a76, v248
    v_accvgpr_write_b32 a77, v249
    v_accvgpr_write_b32 a78, v250
    v_accvgpr_write_b32 a79, v251
    v_accvgpr_read_b32 v248, a80
    v_accvgpr_read_b32 v249, a81
    v_accvgpr_read_b32 v250, a82
    v_accvgpr_read_b32 v251, a83
    v_mul_f32 v248, v248, v242
    v_mul_f32 v249, v249, v242
    v_mul_f32 v250, v250, v242
    v_mul_f32 v251, v251, v242
    v_accvgpr_write_b32 a80, v248
    v_accvgpr_write_b32 a81, v249
    v_accvgpr_write_b32 a82, v250
    v_accvgpr_write_b32 a83, v251
    v_accvgpr_read_b32 v248, a84
    v_accvgpr_read_b32 v249, a85
    v_accvgpr_read_b32 v250, a86
    v_accvgpr_read_b32 v251, a87
    v_mul_f32 v248, v248, v242
    v_mul_f32 v249, v249, v242
    v_mul_f32 v250, v250, v242
    v_mul_f32 v251, v251, v242
    v_accvgpr_write_b32 a84, v248
    v_accvgpr_write_b32 a85, v249
    v_accvgpr_write_b32 a86, v250
    v_accvgpr_write_b32 a87, v251
    v_accvgpr_read_b32 v248, a88
    v_accvgpr_read_b32 v249, a89
    v_accvgpr_read_b32 v250, a90
    v_accvgpr_read_b32 v251, a91
    v_mul_f32 v248, v248, v242
    v_mul_f32 v249, v249, v242
    v_mul_f32 v250, v250, v242
    v_mul_f32 v251, v251, v242
    v_accvgpr_write_b32 a88, v248
    v_accvgpr_write_b32 a89, v249
    v_accvgpr_write_b32 a90, v250
    v_accvgpr_write_b32 a91, v251
    v_accvgpr_read_b32 v248, a92
    v_accvgpr_read_b32 v249, a93
    v_accvgpr_read_b32 v250, a94
    v_accvgpr_read_b32 v251, a95
    v_mul_f32 v248, v248, v242
    v_mul_f32 v249, v249, v242
    v_mul_f32 v250, v250, v242
    v_mul_f32 v251, v251, v242
    v_accvgpr_write_b32 a92, v248
    v_accvgpr_write_b32 a93, v249
    v_accvgpr_write_b32 a94, v250
    v_accvgpr_write_b32 a95, v251
    v_mul_f32 v120, v120, v242
    v_mul_f32 v121, v121, v242
    v_mul_f32 v122, v122, v242
    v_mul_f32 v123, v123, v242
    v_accvgpr_read_b32 v248, a96
    v_accvgpr_read_b32 v249, a97
    v_accvgpr_read_b32 v250, a98
    v_accvgpr_read_b32 v251, a99
    v_mul_f32 v248, v248, v243
    v_mul_f32 v249, v249, v243
    v_mul_f32 v250, v250, v243
    v_mul_f32 v251, v251, v243
    v_accvgpr_write_b32 a96, v248
    v_accvgpr_write_b32 a97, v249
    v_accvgpr_write_b32 a98, v250
    v_accvgpr_write_b32 a99, v251
    v_accvgpr_read_b32 v248, a100
    v_accvgpr_read_b32 v249, a101
    v_accvgpr_read_b32 v250, a102
    v_accvgpr_read_b32 v251, a103
    v_mul_f32 v248, v248, v243
    v_mul_f32 v249, v249, v243
    v_mul_f32 v250, v250, v243
    v_mul_f32 v251, v251, v243
    v_accvgpr_write_b32 a100, v248
    v_accvgpr_write_b32 a101, v249
    v_accvgpr_write_b32 a102, v250
    v_accvgpr_write_b32 a103, v251
    v_accvgpr_read_b32 v248, a104
    v_accvgpr_read_b32 v249, a105
    v_accvgpr_read_b32 v250, a106
    v_accvgpr_read_b32 v251, a107
    v_mul_f32 v248, v248, v243
    v_mul_f32 v249, v249, v243
    v_mul_f32 v250, v250, v243
    v_mul_f32 v251, v251, v243
    v_accvgpr_write_b32 a104, v248
    v_accvgpr_write_b32 a105, v249
    v_accvgpr_write_b32 a106, v250
    v_accvgpr_write_b32 a107, v251
    v_accvgpr_read_b32 v248, a108
    v_accvgpr_read_b32 v249, a109
    v_accvgpr_read_b32 v250, a110
    v_accvgpr_read_b32 v251, a111
    v_mul_f32 v248, v248, v243
    v_mul_f32 v249, v249, v243
    v_mul_f32 v250, v250, v243
    v_mul_f32 v251, v251, v243
    v_accvgpr_write_b32 a108, v248
    v_accvgpr_write_b32 a109, v249
    v_accvgpr_write_b32 a110, v250
    v_accvgpr_write_b32 a111, v251
    v_accvgpr_read_b32 v248, a112
    v_accvgpr_read_b32 v249, a113
    v_accvgpr_read_b32 v250, a114
    v_accvgpr_read_b32 v251, a115
    v_mul_f32 v248, v248, v243
    v_mul_f32 v249, v249, v243
    v_mul_f32 v250, v250, v243
    v_mul_f32 v251, v251, v243
    v_accvgpr_write_b32 a112, v248
    v_accvgpr_write_b32 a113, v249
    v_accvgpr_write_b32 a114, v250
    v_accvgpr_write_b32 a115, v251
    v_accvgpr_read_b32 v248, a116
    v_accvgpr_read_b32 v249, a117
    v_accvgpr_read_b32 v250, a118
    v_accvgpr_read_b32 v251, a119
    v_mul_f32 v248, v248, v243
    v_mul_f32 v249, v249, v243
    v_mul_f32 v250, v250, v243
    v_mul_f32 v251, v251, v243
    v_accvgpr_write_b32 a116, v248
    v_accvgpr_write_b32 a117, v249
    v_accvgpr_write_b32 a118, v250
    v_accvgpr_write_b32 a119, v251
    v_accvgpr_read_b32 v248, a120
    v_accvgpr_read_b32 v249, a121
    v_accvgpr_read_b32 v250, a122
    v_accvgpr_read_b32 v251, a123
    v_mul_f32 v248, v248, v243
    v_mul_f32 v249, v249, v243
    v_mul_f32 v250, v250, v243
    v_mul_f32 v251, v251, v243
    v_accvgpr_write_b32 a120, v248
    v_accvgpr_write_b32 a121, v249
    v_accvgpr_write_b32 a122, v250
    v_accvgpr_write_b32 a123, v251
    v_accvgpr_read_b32 v248, a124
    v_accvgpr_read_b32 v249, a125
    v_accvgpr_read_b32 v250, a126
    v_accvgpr_read_b32 v251, a127
    v_mul_f32 v248, v248, v243
    v_mul_f32 v249, v249, v243
    v_mul_f32 v250, v250, v243
    v_mul_f32 v251, v251, v243
    v_accvgpr_write_b32 a124, v248
    v_accvgpr_write_b32 a125, v249
    v_accvgpr_write_b32 a126, v250
    v_accvgpr_write_b32 a127, v251
    v_mul_f32 v124, v124, v243
    v_mul_f32 v125, v125, v243
    v_mul_f32 v126, v126, v243
    v_mul_f32 v127, v127, v243
    v_accvgpr_read_b32 v248, a128
    v_accvgpr_read_b32 v249, a129
    v_accvgpr_read_b32 v250, a130
    v_accvgpr_read_b32 v251, a131
    v_mul_f32 v248, v248, v244
    v_mul_f32 v249, v249, v244
    v_mul_f32 v250, v250, v244
    v_mul_f32 v251, v251, v244
    v_accvgpr_write_b32 a128, v248
    v_accvgpr_write_b32 a129, v249
    v_accvgpr_write_b32 a130, v250
    v_accvgpr_write_b32 a131, v251
    v_accvgpr_read_b32 v248, a132
    v_accvgpr_read_b32 v249, a133
    v_accvgpr_read_b32 v250, a134
    v_accvgpr_read_b32 v251, a135
    v_mul_f32 v248, v248, v244
    v_mul_f32 v249, v249, v244
    v_mul_f32 v250, v250, v244
    v_mul_f32 v251, v251, v244
    v_accvgpr_write_b32 a132, v248
    v_accvgpr_write_b32 a133, v249
    v_accvgpr_write_b32 a134, v250
    v_accvgpr_write_b32 a135, v251
    v_accvgpr_read_b32 v248, a136
    v_accvgpr_read_b32 v249, a137
    v_accvgpr_read_b32 v250, a138
    v_accvgpr_read_b32 v251, a139
    v_mul_f32 v248, v248, v244
    v_mul_f32 v249, v249, v244
    v_mul_f32 v250, v250, v244
    v_mul_f32 v251, v251, v244
    v_accvgpr_write_b32 a136, v248
    v_accvgpr_write_b32 a137, v249
    v_accvgpr_write_b32 a138, v250
    v_accvgpr_write_b32 a139, v251
    v_accvgpr_read_b32 v248, a140
    v_accvgpr_read_b32 v249, a141
    v_accvgpr_read_b32 v250, a142
    v_accvgpr_read_b32 v251, a143
    v_mul_f32 v248, v248, v244
    v_mul_f32 v249, v249, v244
    v_mul_f32 v250, v250, v244
    v_mul_f32 v251, v251, v244
    v_accvgpr_write_b32 a140, v248
    v_accvgpr_write_b32 a141, v249
    v_accvgpr_write_b32 a142, v250
    v_accvgpr_write_b32 a143, v251
    v_accvgpr_read_b32 v248, a144
    v_accvgpr_read_b32 v249, a145
    v_accvgpr_read_b32 v250, a146
    v_accvgpr_read_b32 v251, a147
    v_mul_f32 v248, v248, v244
    v_mul_f32 v249, v249, v244
    v_mul_f32 v250, v250, v244
    v_mul_f32 v251, v251, v244
    v_accvgpr_write_b32 a144, v248
    v_accvgpr_write_b32 a145, v249
    v_accvgpr_write_b32 a146, v250
    v_accvgpr_write_b32 a147, v251
    v_accvgpr_read_b32 v248, a148
    v_accvgpr_read_b32 v249, a149
    v_accvgpr_read_b32 v250, a150
    v_accvgpr_read_b32 v251, a151
    v_mul_f32 v248, v248, v244
    v_mul_f32 v249, v249, v244
    v_mul_f32 v250, v250, v244
    v_mul_f32 v251, v251, v244
    v_accvgpr_write_b32 a148, v248
    v_accvgpr_write_b32 a149, v249
    v_accvgpr_write_b32 a150, v250
    v_accvgpr_write_b32 a151, v251
    v_accvgpr_read_b32 v248, a152
    v_accvgpr_read_b32 v249, a153
    v_accvgpr_read_b32 v250, a154
    v_accvgpr_read_b32 v251, a155
    v_mul_f32 v248, v248, v244
    v_mul_f32 v249, v249, v244
    v_mul_f32 v250, v250, v244
    v_mul_f32 v251, v251, v244
    v_accvgpr_write_b32 a152, v248
    v_accvgpr_write_b32 a153, v249
    v_accvgpr_write_b32 a154, v250
    v_accvgpr_write_b32 a155, v251
    v_accvgpr_read_b32 v248, a156
    v_accvgpr_read_b32 v249, a157
    v_accvgpr_read_b32 v250, a158
    v_accvgpr_read_b32 v251, a159
    v_mul_f32 v248, v248, v244
    v_mul_f32 v249, v249, v244
    v_mul_f32 v250, v250, v244
    v_mul_f32 v251, v251, v244
    v_accvgpr_write_b32 a156, v248
    v_accvgpr_write_b32 a157, v249
    v_accvgpr_write_b32 a158, v250
    v_accvgpr_write_b32 a159, v251
    v_mul_f32 v128, v128, v244
    v_mul_f32 v129, v129, v244
    v_mul_f32 v130, v130, v244
    v_mul_f32 v131, v131, v244
    v_accvgpr_read_b32 v248, a160
    v_accvgpr_read_b32 v249, a161
    v_accvgpr_read_b32 v250, a162
    v_accvgpr_read_b32 v251, a163
    v_mul_f32 v248, v248, v245
    v_mul_f32 v249, v249, v245
    v_mul_f32 v250, v250, v245
    v_mul_f32 v251, v251, v245
    v_accvgpr_write_b32 a160, v248
    v_accvgpr_write_b32 a161, v249
    v_accvgpr_write_b32 a162, v250
    v_accvgpr_write_b32 a163, v251
    v_accvgpr_read_b32 v248, a164
    v_accvgpr_read_b32 v249, a165
    v_accvgpr_read_b32 v250, a166
    v_accvgpr_read_b32 v251, a167
    v_mul_f32 v248, v248, v245
    v_mul_f32 v249, v249, v245
    v_mul_f32 v250, v250, v245
    v_mul_f32 v251, v251, v245
    v_accvgpr_write_b32 a164, v248
    v_accvgpr_write_b32 a165, v249
    v_accvgpr_write_b32 a166, v250
    v_accvgpr_write_b32 a167, v251
    v_accvgpr_read_b32 v248, a168
    v_accvgpr_read_b32 v249, a169
    v_accvgpr_read_b32 v250, a170
    v_accvgpr_read_b32 v251, a171
    v_mul_f32 v248, v248, v245
    v_mul_f32 v249, v249, v245
    v_mul_f32 v250, v250, v245
    v_mul_f32 v251, v251, v245
    v_accvgpr_write_b32 a168, v248
    v_accvgpr_write_b32 a169, v249
    v_accvgpr_write_b32 a170, v250
    v_accvgpr_write_b32 a171, v251
    v_accvgpr_read_b32 v248, a172
    v_accvgpr_read_b32 v249, a173
    v_accvgpr_read_b32 v250, a174
    v_accvgpr_read_b32 v251, a175
    v_mul_f32 v248, v248, v245
    v_mul_f32 v249, v249, v245
    v_mul_f32 v250, v250, v245
    v_mul_f32 v251, v251, v245
    v_accvgpr_write_b32 a172, v248
    v_accvgpr_write_b32 a173, v249
    v_accvgpr_write_b32 a174, v250
    v_accvgpr_write_b32 a175, v251
    v_accvgpr_read_b32 v248, a176
    v_accvgpr_read_b32 v249, a177
    v_accvgpr_read_b32 v250, a178
    v_accvgpr_read_b32 v251, a179
    v_mul_f32 v248, v248, v245
    v_mul_f32 v249, v249, v245
    v_mul_f32 v250, v250, v245
    v_mul_f32 v251, v251, v245
    v_accvgpr_write_b32 a176, v248
    v_accvgpr_write_b32 a177, v249
    v_accvgpr_write_b32 a178, v250
    v_accvgpr_write_b32 a179, v251
    v_accvgpr_read_b32 v248, a180
    v_accvgpr_read_b32 v249, a181
    v_accvgpr_read_b32 v250, a182
    v_accvgpr_read_b32 v251, a183
    v_mul_f32 v248, v248, v245
    v_mul_f32 v249, v249, v245
    v_mul_f32 v250, v250, v245
    v_mul_f32 v251, v251, v245
    v_accvgpr_write_b32 a180, v248
    v_accvgpr_write_b32 a181, v249
    v_accvgpr_write_b32 a182, v250
    v_accvgpr_write_b32 a183, v251
    v_accvgpr_read_b32 v248, a184
    v_accvgpr_read_b32 v249, a185
    v_accvgpr_read_b32 v250, a186
    v_accvgpr_read_b32 v251, a187
    v_mul_f32 v248, v248, v245
    v_mul_f32 v249, v249, v245
    v_mul_f32 v250, v250, v245
    v_mul_f32 v251, v251, v245
    v_accvgpr_write_b32 a184, v248
    v_accvgpr_write_b32 a185, v249
    v_accvgpr_write_b32 a186, v250
    v_accvgpr_write_b32 a187, v251
    v_accvgpr_read_b32 v248, a188
    v_accvgpr_read_b32 v249, a189
    v_accvgpr_read_b32 v250, a190
    v_accvgpr_read_b32 v251, a191
    v_mul_f32 v248, v248, v245
    v_mul_f32 v249, v249, v245
    v_mul_f32 v250, v250, v245
    v_mul_f32 v251, v251, v245
    v_accvgpr_write_b32 a188, v248
    v_accvgpr_write_b32 a189, v249
    v_accvgpr_write_b32 a190, v250
    v_accvgpr_write_b32 a191, v251
    v_mul_f32 v132, v132, v245
    v_mul_f32 v133, v133, v245
    v_mul_f32 v134, v134, v245
    v_mul_f32 v135, v135, v245
    s_mov_b32 s59, 0
    s_nop 1
    s_setpc_b64 s[62:63]
L_rare2_3:
    s_nop 7
    s_nop 7
    v_accvgpr_read_b32 v248, a0
    v_accvgpr_read_b32 v249, a1
    v_accvgpr_read_b32 v250, a2
    v_accvgpr_read_b32 v251, a3
    v_mul_f32 v248, v248, v240
    v_mul_f32 v249, v249, v240
    v_mul_f32 v250, v250, v240
    v_mul_f32 v251, v251, v240
    v_accvgpr_write_b32 a0, v248
    v_accvgpr_write_b32 a1, v249
    v_accvgpr_write_b32 a2, v250
    v_accvgpr_write_b32 a3, v251
    v_accvgpr_read_b32 v248, a4
    v_accvgpr_read_b32 v249, a5
    v_accvgpr_read_b32 v250, a6
    v_accvgpr_read_b32 v251, a7
    v_mul_f32 v248, v248, v240
    v_mul_f32 v249, v249, v240
    v_mul_f32 v250, v250, v240
    v_mul_f32 v251, v251, v240
    v_accvgpr_write_b32 a4, v248
    v_accvgpr_write_b32 a5, v249
    v_accvgpr_write_b32 a6, v250
    v_accvgpr_write_b32 a7, v251
    v_accvgpr_read_b32 v248, a8
    v_accvgpr_read_b32 v249, a9
    v_accvgpr_read_b32 v250, a10
    v_accvgpr_read_b32 v251, a11
    v_mul_f32 v248, v248, v240
    v_mul_f32 v249, v249, v240
    v_mul_f32 v250, v250, v240
    v_mul_f32 v251, v251, v240
    v_accvgpr_write_b32 a8, v248
    v_accvgpr_write_b32 a9, v249
    v_accvgpr_write_b32 a10, v250
    v_accvgpr_write_b32 a11, v251
    v_accvgpr_read_b32 v248, a12
    v_accvgpr_read_b32 v249, a13
    v_accvgpr_read_b32 v250, a14
    v_accvgpr_read_b32 v251, a15
    v_mul_f32 v248, v248, v240
    v_mul_f32 v249, v249, v240
    v_mul_f32 v250, v250, v240
    v_mul_f32 v251, v251, v240
    v_accvgpr_write_b32 a12, v248
    v_accvgpr_write_b32 a13, v249
    v_accvgpr_write_b32 a14, v250
    v_accvgpr_write_b32 a15, v251
    v_accvgpr_read_b32 v248, a16
    v_accvgpr_read_b32 v249, a17
    v_accvgpr_read_b32 v250, a18
    v_accvgpr_read_b32 v251, a19
    v_mul_f32 v248, v248, v240
    v_mul_f32 v249, v249, v240
    v_mul_f32 v250, v250, v240
    v_mul_f32 v251, v251, v240
    v_accvgpr_write_b32 a16, v248
    v_accvgpr_write_b32 a17, v249
    v_accvgpr_write_b32 a18, v250
    v_accvgpr_write_b32 a19, v251
    v_accvgpr_read_b32 v248, a20
    v_accvgpr_read_b32 v249, a21
    v_accvgpr_read_b32 v250, a22
    v_accvgpr_read_b32 v251, a23
    v_mul_f32 v248, v248, v240
    v_mul_f32 v249, v249, v240
    v_mul_f32 v250, v250, v240
    v_mul_f32 v251, v251, v240
    v_accvgpr_write_b32 a20, v248
    v_accvgpr_write_b32 a21, v249
    v_accvgpr_write_b32 a22, v250
    v_accvgpr_write_b32 a23, v251
    v_accvgpr_read_b32 v248, a24
    v_accvgpr_read_b32 v249, a25
    v_accvgpr_read_b32 v250, a26
    v_accvgpr_read_b32 v251, a27
    v_mul_f32 v248, v248, v240
    v_mul_f32 v249, v249, v240
    v_mul_f32 v250, v250, v240
    v_mul_f32 v251, v251, v240
    v_accvgpr_write_b32 a24, v248
    v_accvgpr_write_b32 a25, v249
    v_accvgpr_write_b32 a26, v250
    v_accvgpr_write_b32 a27, v251
    v_accvgpr_read_b32 v248, a28
    v_accvgpr_read_b32 v249, a29
    v_accvgpr_read_b32 v250, a30
    v_accvgpr_read_b32 v251, a31
    v_mul_f32 v248, v248, v240
    v_mul_f32 v249, v249, v240
    v_mul_f32 v250, v250, v240
    v_mul_f32 v251, v251, v240
    v_accvgpr_write_b32 a28, v248
    v_accvgpr_write_b32 a29, v249
    v_accvgpr_write_b32 a30, v250
    v_accvgpr_write_b32 a31, v251
    v_mul_f32 v112, v112, v240
    v_mul_f32 v113, v113, v240
    v_mul_f32 v114, v114, v240
    v_mul_f32 v115, v115, v240
    v_accvgpr_read_b32 v248, a32
    v_accvgpr_read_b32 v249, a33
    v_accvgpr_read_b32 v250, a34
    v_accvgpr_read_b32 v251, a35
    v_mul_f32 v248, v248, v241
    v_mul_f32 v249, v249, v241
    v_mul_f32 v250, v250, v241
    v_mul_f32 v251, v251, v241
    v_accvgpr_write_b32 a32, v248
    v_accvgpr_write_b32 a33, v249
    v_accvgpr_write_b32 a34, v250
    v_accvgpr_write_b32 a35, v251
    v_accvgpr_read_b32 v248, a36
    v_accvgpr_read_b32 v249, a37
    v_accvgpr_read_b32 v250, a38
    v_accvgpr_read_b32 v251, a39
    v_mul_f32 v248, v248, v241
    v_mul_f32 v249, v249, v241
    v_mul_f32 v250, v250, v241
    v_mul_f32 v251, v251, v241
    v_accvgpr_write_b32 a36, v248
    v_accvgpr_write_b32 a37, v249
    v_accvgpr_write_b32 a38, v250
    v_accvgpr_write_b32 a39, v251
    v_accvgpr_read_b32 v248, a40
    v_accvgpr_read_b32 v249, a41
    v_accvgpr_read_b32 v250, a42
    v_accvgpr_read_b32 v251, a43
    v_mul_f32 v248, v248, v241
    v_mul_f32 v249, v249, v241
    v_mul_f32 v250, v250, v241
    v_mul_f32 v251, v251, v241
    v_accvgpr_write_b32 a40, v248
    v_accvgpr_write_b32 a41, v249
    v_accvgpr_write_b32 a42, v250
    v_accvgpr_write_b32 a43, v251
    v_accvgpr_read_b32 v248, a44
    v_accvgpr_read_b32 v249, a45
    v_accvgpr_read_b32 v250, a46
    v_accvgpr_read_b32 v251, a47
    v_mul_f32 v248, v248, v241
    v_mul_f32 v249, v249, v241
    v_mul_f32 v250, v250, v241
    v_mul_f32 v251, v251, v241
    v_accvgpr_write_b32 a44, v248
    v_accvgpr_write_b32 a45, v249
    v_accvgpr_write_b32 a46, v250
    v_accvgpr_write_b32 a47, v251
    v_accvgpr_read_b32 v248, a48
    v_accvgpr_read_b32 v249, a49
    v_accvgpr_read_b32 v250, a50
    v_accvgpr_read_b32 v251, a51
    v_mul_f32 v248, v248, v241
    v_mul_f32 v249, v249, v241
    v_mul_f32 v250, v250, v241
    v_mul_f32 v251, v251, v241
    v_accvgpr_write_b32 a48, v248
    v_accvgpr_write_b32 a49, v249
    v_accvgpr_write_b32 a50, v250
    v_accvgpr_write_b32 a51, v251
    v_accvgpr_read_b32 v248, a52
    v_accvgpr_read_b32 v249, a53
    v_accvgpr_read_b32 v250, a54
    v_accvgpr_read_b32 v251, a55
    v_mul_f32 v248, v248, v241
    v_mul_f32 v249, v249, v241
    v_mul_f32 v250, v250, v241
    v_mul_f32 v251, v251, v241
    v_accvgpr_write_b32 a52, v248
    v_accvgpr_write_b32 a53, v249
    v_accvgpr_write_b32 a54, v250
    v_accvgpr_write_b32 a55, v251
    v_accvgpr_read_b32 v248, a56
    v_accvgpr_read_b32 v249, a57
    v_accvgpr_read_b32 v250, a58
    v_accvgpr_read_b32 v251, a59
    v_mul_f32 v248, v248, v241
    v_mul_f32 v249, v249, v241
    v_mul_f32 v250, v250, v241
    v_mul_f32 v251, v251, v241
    v_accvgpr_write_b32 a56, v248
    v_accvgpr_write_b32 a57, v249
    v_accvgpr_write_b32 a58, v250
    v_accvgpr_write_b32 a59, v251
    v_accvgpr_read_b32 v248, a60
    v_accvgpr_read_b32 v249, a61
    v_accvgpr_read_b32 v250, a62
    v_accvgpr_read_b32 v251, a63
    v_mul_f32 v248, v248, v241
    v_mul_f32 v249, v249, v241
    v_mul_f32 v250, v250, v241
    v_mul_f32 v251, v251, v241
    v_accvgpr_write_b32 a60, v248
    v_accvgpr_write_b32 a61, v249
    v_accvgpr_write_b32 a62, v250
    v_accvgpr_write_b32 a63, v251
    v_mul_f32 v116, v116, v241
    v_mul_f32 v117, v117, v241
    v_mul_f32 v118, v118, v241
    v_mul_f32 v119, v119, v241
    v_accvgpr_read_b32 v248, a64
    v_accvgpr_read_b32 v249, a65
    v_accvgpr_read_b32 v250, a66
    v_accvgpr_read_b32 v251, a67
    v_mul_f32 v248, v248, v242
    v_mul_f32 v249, v249, v242
    v_mul_f32 v250, v250, v242
    v_mul_f32 v251, v251, v242
    v_accvgpr_write_b32 a64, v248
    v_accvgpr_write_b32 a65, v249
    v_accvgpr_write_b32 a66, v250
    v_accvgpr_write_b32 a67, v251
    v_accvgpr_read_b32 v248, a68
    v_accvgpr_read_b32 v249, a69
    v_accvgpr_read_b32 v250, a70
    v_accvgpr_read_b32 v251, a71
    v_mul_f32 v248, v248, v242
    v_mul_f32 v249, v249, v242
    v_mul_f32 v250, v250, v242
    v_mul_f32 v251, v251, v242
    v_accvgpr_write_b32 a68, v248
    v_accvgpr_write_b32 a69, v249
    v_accvgpr_write_b32 a70, v250
    v_accvgpr_write_b32 a71, v251
    v_accvgpr_read_b32 v248, a72
    v_accvgpr_read_b32 v249, a73
    v_accvgpr_read_b32 v250, a74
    v_accvgpr_read_b32 v251, a75
    v_mul_f32 v248, v248, v242
    v_mul_f32 v249, v249, v242
    v_mul_f32 v250, v250, v242
    v_mul_f32 v251, v251, v242
    v_accvgpr_write_b32 a72, v248
    v_accvgpr_write_b32 a73, v249
    v_accvgpr_write_b32 a74, v250
    v_accvgpr_write_b32 a75, v251
    v_accvgpr_read_b32 v248, a76
    v_accvgpr_read_b32 v249, a77
    v_accvgpr_read_b32 v250, a78
    v_accvgpr_read_b32 v251, a79
    v_mul_f32 v248, v248, v242
    v_mul_f32 v249, v249, v242
    v_mul_f32 v250, v250, v242
    v_mul_f32 v251, v251, v242
    v_accvgpr_write_b32 a76, v248
    v_accvgpr_write_b32 a77, v249
    v_accvgpr_write_b32 a78, v250
    v_accvgpr_write_b32 a79, v251
    v_accvgpr_read_b32 v248, a80
    v_accvgpr_read_b32 v249, a81
    v_accvgpr_read_b32 v250, a82
    v_accvgpr_read_b32 v251, a83
    v_mul_f32 v248, v248, v242
    v_mul_f32 v249, v249, v242
    v_mul_f32 v250, v250, v242
    v_mul_f32 v251, v251, v242
    v_accvgpr_write_b32 a80, v248
    v_accvgpr_write_b32 a81, v249
    v_accvgpr_write_b32 a82, v250
    v_accvgpr_write_b32 a83, v251
    v_accvgpr_read_b32 v248, a84
    v_accvgpr_read_b32 v249, a85
    v_accvgpr_read_b32 v250, a86
    v_accvgpr_read_b32 v251, a87
    v_mul_f32 v248, v248, v242
    v_mul_f32 v249, v249, v242
    v_mul_f32 v250, v250, v242
    v_mul_f32 v251, v251, v242
    v_accvgpr_write_b32 a84, v248
    v_accvgpr_write_b32 a85, v249
    v_accvgpr_write_b32 a86, v250
    v_accvgpr_write_b32 a87, v251
    v_accvgpr_read_b32 v248, a88
    v_accvgpr_read_b32 v249, a89
    v_accvgpr_read_b32 v250, a90
    v_accvgpr_read_b32 v251, a91
    v_mul_f32 v248, v248, v242
    v_mul_f32 v249, v249, v242
    v_mul_f32 v250, v250, v242
    v_mul_f32 v251, v251, v242
    v_accvgpr_write_b32 a88, v248
    v_accvgpr_write_b32 a89, v249
    v_accvgpr_write_b32 a90, v250
    v_accvgpr_write_b32 a91, v251
    v_accvgpr_read_b32 v248, a92
    v_accvgpr_read_b32 v249, a93
    v_accvgpr_read_b32 v250, a94
    v_accvgpr_read_b32 v251, a95
    v_mul_f32 v248, v248, v242
    v_mul_f32 v249, v249, v242
    v_mul_f32 v250, v250, v242
    v_mul_f32 v251, v251, v242
    v_accvgpr_write_b32 a92, v248
    v_accvgpr_write_b32 a93, v249
    v_accvgpr_write_b32 a94, v250
    v_accvgpr_write_b32 a95, v251
    v_mul_f32 v120, v120, v242
    v_mul_f32 v121, v121, v242
    v_mul_f32 v122, v122, v242
    v_mul_f32 v123, v123, v242
    s_mov_b32 s59, 0
    s_nop 1
    s_setpc_b64 s[62:63]
.section .rodata,"a"
.p2align 6
.amdhsa_kernel concat_heads__gqa_block_cached__mha_block_cached__near_ridge_kernel
  .amdhsa_next_free_vgpr 512
  .amdhsa_next_free_sgpr 102
  .amdhsa_accum_offset 256
  .amdhsa_group_segment_fixed_size 0
  .amdhsa_kernarg_size 104
  .amdhsa_user_sgpr_count 2
  .amdhsa_user_sgpr_kernarg_segment_ptr 1
  .amdhsa_system_sgpr_workgroup_id_x 1
.end_amdhsa_kernel
```
